```python
import torch

def _softmax(x, axis=-1):
    return torch.softmax(x, dim=axis)
def _gelu(x):
    return torch.nn.functional.gelu(x, approximate="tanh")
def _silu(x):
    return torch.nn.functional.silu(x)
def _sigmoid(x):
    return torch.sigmoid(x)
def _layernorm(x, axis=-1, eps=1e-5):
    m = x.mean(dim=axis, keepdim=True)
    v = x.var(dim=axis, keepdim=True, unbiased=False)
    return (x - m) / torch.sqrt(v + eps)
def _scatter_add(tgt, idx, src, axis=0):
    return tgt.clone().index_add_(axis, idx, src)
def _segment_sum(src, seg, n):
    out = torch.zeros((n,) + src.shape[1:], dtype=src.dtype)
    return out.index_add_(0, seg, src)
def _pad(x, pw):
    flat = tuple(v for pair in reversed(pw) for v in pair)
    return torch.nn.functional.pad(x, flat)

kernel_name = 'gated_mix__linear_attn_block__mha_block__prompt'

def setup_inputs():

    _w = (lambda a: (lambda t: t.to(torch.bfloat16) if t.is_floating_point() else t)(torch.as_tensor(a)))
    def _A_setup():
        B, S, D = 1, 2048, 448
        return {
            "x": _w((lambda *s: torch.randn(*s, dtype=torch.bfloat16) * 0.05)(B, S, D)),
            "wqkv": _w((lambda *s: torch.randn(*s, dtype=torch.bfloat16) * 3.2)(D, 3 * D)),
            "wo": _w((lambda *s: torch.randn(*s, dtype=torch.bfloat16) * 0.4)(D, D)),
        }
    _A_in = _A_setup()

    def _B_setup():
        B, S, D, H = 1, 2048, 448, 16
        return {
            "x": _w((lambda *s: torch.randn(*s, dtype=torch.bfloat16) * 0.05)(B, S, D)),
            "wqkv": _w((lambda *s: torch.randn(*s, dtype=torch.bfloat16) * 1.6)(D, 3 * D)),
            "wo": _w((lambda *s: torch.randn(*s, dtype=torch.bfloat16) * 0.05)(D, D)),
        }
    _B_in = _B_setup()

    return {
        "A_x": _A_in["x"],
        "A_wqkv": _A_in["wqkv"],
        "A_wo": _A_in["wo"],
        "B_x": _B_in["x"],
        "B_wqkv": _B_in["wqkv"],
        "B_wo": _B_in["wo"],
        "gate_w": _w((lambda *s: torch.randn(*s, dtype=torch.bfloat16) * 0.05)(448) * 16.0),
    }

def reference(A_x, A_wqkv, A_wo, B_x, B_wqkv, B_wo, gate_w):
    def _A_ref(x, wqkv, wo):
        B, S, D = x.shape
        H = 16; Dh = D // H
        qkv = (lambda x, *d: x.permute(*d))((x @ wqkv).reshape(B, S, 3, H, Dh), 2, 0, 3, 1, 4)
        q, k, v = qkv[0], qkv[1], qkv[2]
        phi = lambda t: torch.where(t > 0, t + 1, torch.exp(t)) + 1e-6
        pq, pk = phi(q), phi(k)
        kv = torch.einsum("bhsd,bhse->bhde", pk, v)
        z = torch.einsum("bhsd->bhd", pk)
        num = torch.einsum("bhqd,bhde->bhqe", pq, kv)
        den = torch.einsum("bhqd,bhd->bhq", pq, z)[..., None] + 1e-6
        o = num / den
        return (lambda x, *d: x.permute(*d))(o, 0, 2, 1, 3).reshape(B, S, D) @ wo

    def _B_ref(x, wqkv, wo):
        B, S, D = x.shape
        H = 16
        Dh = D // H
        qkv = (lambda x, *d: x.permute(*d))((x @ wqkv).reshape(B, S, 3, H, Dh), 2, 0, 3, 1, 4)
        q, k, v = qkv[0], qkv[1], qkv[2]
        scores = torch.einsum("bhqd,bhkd->bhqk", q, k) * (Dh ** -0.5)
        p = _softmax(scores, axis=-1)
        o = torch.einsum("bhqk,bhkd->bhqd", p, v)
        return (lambda x, *d: x.permute(*d))(o, 0, 2, 1, 3).reshape(B, S, D) @ wo

    x = A_x
    g = _sigmoid((x * gate_w).sum(-1, keepdims=True))
    a = _A_ref(x, A_wqkv, A_wo)
    b = _B_ref(x, B_wqkv, B_wo)
    return g * a + (1 - g) * b
```

```asm
; @launch grid=(256,1,1) block=(512,1,1) lds=163840
.amdgcn_target "amdgcn-amd-amdhsa--gfx950"
.text
.globl gated_mix__linear_attn_block__mha_block__prompt_kernel
.p2align 8
.type gated_mix__linear_attn_block__mha_block__prompt_kernel,@function
gated_mix__linear_attn_block__mha_block__prompt_kernel:
    s_cmp_ge_u32 s2, 256
    s_cbranch_scc1 L_END
    s_load_dwordx16 s[4:19], s[0:1], 0
    s_load_dwordx4 s[20:23], s[0:1], 64
    s_getpc_b64 s[40:41]
L_PC:
    s_mov_b32 s42, L_CODE_END-L_PC
    s_mov_b32 s43, 0x20000
    v_lshlrev_b32 v1, 7, v0
    buffer_load_dword a89, v1, s[40:43], 0 offen
    v_lshrrev_b32 v1, 6, v0
    v_and_b32 v0, 63, v0
    v_readfirstlane_b32 s27, v1
    s_and_b32 s25, s2, 7
    s_lshl_b32 s64, s25, 2
    s_lshr_b32 s25, 0x36047215, s64
    s_and_b32 s25, s25, 7
    s_lshr_b32 s24, s2, 4
    s_bfe_u32 s26, s2, 0x10003
    s_lshl_b32 s64, s25, 2
    s_lshr_b32 s91, 0x04152630, s64
    s_and_b32 s91, s91, 7
    s_cmp_ge_u32 s27, 4
    s_cbranch_scc0 L_COMPUTE
    s_sub_u32 s27, s27, 4
    v_lshrrev_b32 v1, 3, v0
    s_lshl_b32 s64, s24, 2
    s_add_u32 s64, s64, s27
    s_mul_i32 s64, s64, 28672
    v_mul_u32_u24 v1, 896, v1
    v_lshrrev_b32 v2, 4, v0
    v_and_b32 v3, 7, v0
    v_xor_b32 v2, v2, v3
    v_lshlrev_b32 v2, 4, v2
    v_add3_u32 v2, v2, v1, s64
    v_xor_b32 v3, 64, v2
    v_add_u32 v3, 7168, v3
    v_add_u32 v4, 14336, v2
    v_add_u32 v5, 14336, v3
    s_lshl_b32 s66, s27, 12
    s_mov_b32 s38, 1835008
    s_mov_b32 s39, 0x20000
    s_mov_b32 s80, s91
    s_waitcnt lgkmcnt(0)
    s_mov_b32 s36, s4
    s_mov_b32 s37, s5
    s_lshl_b32 s64, s80, 14
    s_add_u32 s69, s64, s66
    s_add_u32 m0, s69, 0
    s_lshl_b32 s64, s80, 7
    buffer_load_dwordx4 v2, s[36:39], s64 offen lds
    s_add_u32 m0, s69, 1024
    s_nop 0
    buffer_load_dwordx4 v3, s[36:39], s64 offen lds
    s_add_u32 m0, s69, 2048
    s_nop 0
    buffer_load_dwordx4 v4, s[36:39], s64 offen lds
    s_add_u32 m0, s69, 3072
    s_nop 0
    buffer_load_dwordx4 v5, s[36:39], s64 offen lds
    v_lshrrev_b32 v10, 4, v0
    v_bfe_u32 v11, v0, 2, 2
    v_and_b32 v6, 1, v10
    v_xor_b32 v11, v11, v6
    v_lshrrev_b32 v6, 1, v11
    v_lshl_add_u32 v10, v10, 1, v6
    v_mul_u32_u24 v10, 2688, v10
    v_and_b32 v11, 1, v11
    v_lshl_add_u32 v10, v11, 6, v10
    v_and_b32 v11, 3, v0
    v_lshl_add_u32 v6, v11, 4, v10
    v_and_b32 v10, 112, v6
    v_cmp_eq_u32 vcc, 112, v10
    v_subrev_u32 v10, 16, v6
    s_nop 0
    v_cndmask_b32 v6, v6, v10, vcc
    s_mul_i32 s64, s27, 43008
    s_mul_i32 s65, s25, 112
    s_add_u32 s64, s64, s65
    s_add_u32 s64, s64, 896
    v_add_u32 v6, s64, v6
    v_add_u32 v7, 21504, v6
    v_add_u32 v8, 896, v6
    v_add_u32 v9, 896, v7
    s_lshl_b32 s67, s27, 11
    s_add_u32 s67, s67, 114688
    s_mov_b32 s42, 1204224
    s_mov_b32 s43, 0x20000
    s_cmp_eq_u32 s26, 0
    s_cselect_b32 s40, s6, s12
    s_cselect_b32 s41, s7, s13
    s_add_u32 m0, s67, 0
    s_mul_i32 s65, s80, 172032
    buffer_load_dwordx4 v6, s[40:43], s65 offen lds
    s_add_u32 m0, s67, 1024
    s_nop 0
    buffer_load_dwordx4 v7, s[40:43], s65 offen lds
    s_add_u32 m0, s67, 8192
    s_nop 0
    buffer_load_dwordx4 v8, s[40:43], s65 offen lds
    s_add_u32 m0, s67, 9216
    s_nop 0
    buffer_load_dwordx4 v9, s[40:43], s65 offen lds
    s_add_u32 s81, s80, 1
    s_cmp_eq_u32 s81, 7
    s_cselect_b32 s81, 0, s81
    s_add_u32 s82, s81, 1
    s_cmp_eq_u32 s82, 7
    s_cselect_b32 s82, 0, s82
    s_add_u32 s83, s82, 1
    s_cmp_eq_u32 s83, 7
    s_cselect_b32 s83, 0, s83
    s_add_u32 s84, s83, 1
    s_cmp_eq_u32 s84, 7
    s_cselect_b32 s84, 0, s84
    s_add_u32 s85, s84, 1
    s_cmp_eq_u32 s85, 7
    s_cselect_b32 s85, 0, s85
    s_add_u32 s86, s85, 1
    s_cmp_eq_u32 s86, 7
    s_cselect_b32 s86, 0, s86
    s_lshl_b32 s64, s81, 14
    s_add_u32 s69, s64, s66
    s_add_u32 m0, s69, 0
    s_lshl_b32 s64, s81, 7
    buffer_load_dwordx4 v2, s[36:39], s64 offen lds
    s_add_u32 m0, s69, 1024
    s_nop 0
    buffer_load_dwordx4 v3, s[36:39], s64 offen lds
    s_add_u32 m0, s69, 2048
    s_nop 0
    buffer_load_dwordx4 v4, s[36:39], s64 offen lds
    s_add_u32 m0, s69, 3072
    s_nop 0
    buffer_load_dwordx4 v5, s[36:39], s64 offen lds
    s_add_u32 m0, s67, 16384
    s_mul_i32 s65, s81, 172032
    buffer_load_dwordx4 v6, s[40:43], s65 offen lds
    s_add_u32 m0, s67, 17408
    s_nop 0
    buffer_load_dwordx4 v7, s[40:43], s65 offen lds
    s_add_u32 m0, s67, 24576
    s_nop 0
    buffer_load_dwordx4 v8, s[40:43], s65 offen lds
    s_add_u32 m0, s67, 25600
    s_nop 0
    buffer_load_dwordx4 v9, s[40:43], s65 offen lds
    s_lshl_b32 s64, s82, 14
    s_add_u32 s69, s64, s66
    s_add_u32 m0, s69, 0
    s_lshl_b32 s64, s82, 7
    buffer_load_dwordx4 v2, s[36:39], s64 offen lds
    s_add_u32 m0, s69, 1024
    s_nop 0
    buffer_load_dwordx4 v3, s[36:39], s64 offen lds
    s_add_u32 m0, s69, 2048
    s_nop 0
    buffer_load_dwordx4 v4, s[36:39], s64 offen lds
    s_add_u32 m0, s69, 3072
    s_nop 0
    buffer_load_dwordx4 v5, s[36:39], s64 offen lds
    s_lshr_b32 s32, s2, 3
    s_lshr_b32 s33, s25, 2
    s_lshr_b32 s34, s24, 2
    s_and_b32 s29, s24, 3
    s_lshl_b32 s28, s25, 1
    s_cmp_eq_u32 s26, s33
    s_addc_u32 s28, s28, 0
    s_mul_i32 s30, s32, 37
    s_lshr_b32 s30, s30, 8
    s_mul_i32 s31, s30, 7
    s_sub_u32 s31, s32, s31
    s_and_b32 s64, s2, 7
    s_lshl_b32 s64, s64, 2
    s_add_u32 s30, s30, s64
    s_mov_b32 s44, s6
    s_mov_b32 s45, s7
    s_mov_b32 s46, 1204224
    s_mov_b32 s47, 0x20000
    s_mov_b32 s48, s12
    s_mov_b32 s49, s13
    s_mov_b32 s50, 1204224
    s_mov_b32 s51, 0x20000
    s_mov_b32 s52, s22
    s_mov_b32 s53, s23
    s_mov_b32 s54, 16777216
    s_mov_b32 s55, 0x20000
    s_mov_b32 s56, s20
    s_mov_b32 s57, s21
    s_mov_b32 s58, 256
    s_mov_b32 s59, 0x20000
    s_mov_b32 s60, s16
    s_mov_b32 s61, s17
    s_mov_b32 s62, 896
    s_mov_b32 s63, 0x20000
    v_lshrrev_b32 v10, 2, v0
    v_mul_u32_u24 v10, 2688, v10
    v_and_b32 v11, 3, v0
    v_lshl_add_u32 v10, v11, 4, v10
    s_mul_i32 s65, s28, 56
    s_mul_i32 s64, s27, 129024
    s_add_u32 s64, s64, s65
    s_add_u32 s64, s64, 688128
    v_add_u32 v11, s64, v10
    s_mul_i32 s64, s27, 172032
    s_add_u32 s64, s64, s65
    v_add_u32 v10, s64, v10
    s_lshl_b32 s88, s27, 12
    s_add_u32 s88, s88, 114688
    s_mul_i32 s89, s27, 3072
    s_add_u32 s89, s89, 114688
    s_add_u32 s64, s88, 16440
    v_lshl_add_u32 v15, v0, 6, s64
    s_add_u32 s64, s89, 32824
    v_lshl_add_u32 v16, v0, 6, s64
    s_lshl_b32 s64, s27, 7
    v_lshl_add_u32 v14, v0, 1, s64
    s_mul_i32 s64, s27, 96
    s_add_u32 s64, s64, 512
    v_lshl_add_u32 v17, v0, 1, s64
    v_mov_b32 v18, 0
    s_waitcnt vmcnt(12)
    s_barrier
    s_add_u32 m0, s67, 32768
    s_mul_i32 s65, s82, 172032
    buffer_load_dwordx4 v6, s[40:43], s65 offen lds
    s_add_u32 m0, s67, 33792
    s_nop 0
    buffer_load_dwordx4 v7, s[40:43], s65 offen lds
    s_add_u32 m0, s67, 40960
    s_nop 0
    buffer_load_dwordx4 v8, s[40:43], s65 offen lds
    s_add_u32 m0, s67, 41984
    s_nop 0
    buffer_load_dwordx4 v9, s[40:43], s65 offen lds
    s_lshl_b32 s64, s83, 14
    s_add_u32 s69, s64, s66
    s_add_u32 m0, s69, 0
    s_lshl_b32 s64, s83, 7
    buffer_load_dwordx4 v2, s[36:39], s64 offen lds
    s_add_u32 m0, s69, 1024
    s_nop 0
    buffer_load_dwordx4 v3, s[36:39], s64 offen lds
    s_add_u32 m0, s69, 2048
    s_nop 0
    buffer_load_dwordx4 v4, s[36:39], s64 offen lds
    s_add_u32 m0, s69, 3072
    s_nop 0
    buffer_load_dwordx4 v5, s[36:39], s64 offen lds
    s_waitcnt vmcnt(12)
    s_barrier
    s_add_u32 m0, s67, 0
    s_mul_i32 s65, s83, 172032
    buffer_load_dwordx4 v6, s[40:43], s65 offen lds
    s_add_u32 m0, s67, 1024
    s_nop 0
    buffer_load_dwordx4 v7, s[40:43], s65 offen lds
    s_add_u32 m0, s67, 8192
    s_nop 0
    buffer_load_dwordx4 v8, s[40:43], s65 offen lds
    s_add_u32 m0, s67, 9216
    s_nop 0
    buffer_load_dwordx4 v9, s[40:43], s65 offen lds
    s_lshl_b32 s64, s84, 14
    s_add_u32 s69, s64, s66
    s_add_u32 m0, s69, 0
    s_lshl_b32 s64, s84, 7
    buffer_load_dwordx4 v2, s[36:39], s64 offen lds
    s_add_u32 m0, s69, 1024
    s_nop 0
    buffer_load_dwordx4 v3, s[36:39], s64 offen lds
    s_add_u32 m0, s69, 2048
    s_nop 0
    buffer_load_dwordx4 v4, s[36:39], s64 offen lds
    s_add_u32 m0, s69, 3072
    s_nop 0
    buffer_load_dwordx4 v5, s[36:39], s64 offen lds
    buffer_load_ushort v12, v14, s[60:63], 0 offen
    buffer_load_ushort v13, v17, s[60:63], 0 offen
    s_waitcnt vmcnt(14)
    s_barrier
    s_add_u32 m0, s67, 16384
    s_mul_i32 s65, s84, 172032
    buffer_load_dwordx4 v6, s[40:43], s65 offen lds
    s_add_u32 m0, s67, 17408
    s_nop 0
    buffer_load_dwordx4 v7, s[40:43], s65 offen lds
    s_add_u32 m0, s67, 24576
    s_nop 0
    buffer_load_dwordx4 v8, s[40:43], s65 offen lds
    s_add_u32 m0, s67, 25600
    s_nop 0
    buffer_load_dwordx4 v9, s[40:43], s65 offen lds
    s_lshl_b32 s64, s85, 14
    s_add_u32 s69, s64, s66
    s_add_u32 m0, s69, 0
    s_lshl_b32 s64, s85, 7
    buffer_load_dwordx4 v2, s[36:39], s64 offen lds
    s_add_u32 m0, s69, 1024
    s_nop 0
    buffer_load_dwordx4 v3, s[36:39], s64 offen lds
    s_add_u32 m0, s69, 2048
    s_nop 0
    buffer_load_dwordx4 v4, s[36:39], s64 offen lds
    s_add_u32 m0, s69, 3072
    s_nop 0
    buffer_load_dwordx4 v5, s[36:39], s64 offen lds
    s_waitcnt vmcnt(14)
    s_barrier
    s_add_u32 m0, s67, 32768
    s_mul_i32 s65, s85, 172032
    buffer_load_dwordx4 v6, s[40:43], s65 offen lds
    s_add_u32 m0, s67, 33792
    s_nop 0
    buffer_load_dwordx4 v7, s[40:43], s65 offen lds
    s_add_u32 m0, s67, 40960
    s_nop 0
    buffer_load_dwordx4 v8, s[40:43], s65 offen lds
    s_add_u32 m0, s67, 41984
    s_nop 0
    buffer_load_dwordx4 v9, s[40:43], s65 offen lds
    s_lshl_b32 s64, s86, 14
    s_add_u32 s69, s64, s66
    s_add_u32 m0, s69, 0
    s_lshl_b32 s64, s86, 7
    buffer_load_dwordx4 v2, s[36:39], s64 offen lds
    s_add_u32 m0, s69, 1024
    s_nop 0
    buffer_load_dwordx4 v3, s[36:39], s64 offen lds
    s_add_u32 m0, s69, 2048
    s_nop 0
    buffer_load_dwordx4 v4, s[36:39], s64 offen lds
    s_add_u32 m0, s69, 3072
    s_nop 0
    buffer_load_dwordx4 v5, s[36:39], s64 offen lds
    buffer_load_dword v17, v18, s[56:59], 0 offen sc1
    s_waitcnt vmcnt(13)
    s_barrier
    s_add_u32 m0, s67, 0
    s_mul_i32 s65, s86, 172032
    buffer_load_dwordx4 v6, s[40:43], s65 offen lds
    s_add_u32 m0, s67, 1024
    s_nop 0
    buffer_load_dwordx4 v7, s[40:43], s65 offen lds
    s_add_u32 m0, s67, 8192
    s_nop 0
    buffer_load_dwordx4 v8, s[40:43], s65 offen lds
    s_add_u32 m0, s67, 9216
    s_nop 0
    buffer_load_dwordx4 v9, s[40:43], s65 offen lds
    s_waitcnt vmcnt(9)
    s_barrier
    s_add_u32 m0, s88, 16384
    s_mov_b32 s65, 0
    buffer_load_dwordx4 v10, s[48:51], s65 offen lds
    s_add_u32 m0, s88, 17408
    s_mov_b32 s65, 43008
    buffer_load_dwordx4 v10, s[48:51], s65 offen lds
    s_add_u32 m0, s88, 18432
    s_mov_b32 s65, 86016
    buffer_load_dwordx4 v10, s[48:51], s65 offen lds
    s_add_u32 m0, s88, 19456
    s_mov_b32 s65, 129024
    buffer_load_dwordx4 v10, s[48:51], s65 offen lds
    s_waitcnt vmcnt(4)
    s_barrier
    s_lshl_b32 s64, s25, 4
    s_add_u32 s64, s64, s24
    s_lshl_b32 s64, s64, 7
    s_add_u32 s66, s64, 5242880
    v_readfirstlane_b32 s87, v17
    s_nop 0
    s_cmp_lg_u32 s87, 0
    s_cbranch_scc1 H_INIT_OKA
    s_mov_b64 exec, 1
    s_mov_b32 s68, 200000
    s_mov_b64 vcc, exec
POLLS_INITA:
    s_mov_b64 exec, vcc
POLL_INITA:
    buffer_load_dword v17, v18, s[56:59], 0 offen sc1
    s_sub_u32 s68, s68, 1
    s_cbranch_scc1 POLLX_INITA
    s_waitcnt vmcnt(0)
    v_cmp_eq_u32 vcc, 0, v17
    s_cbranch_vccnz POLLS_INITA
POLLX_INITA:
    s_mov_b64 exec, -1
    v_readfirstlane_b32 s87, v17
H_INIT_OKA:
    s_add_u32 m0, s89, 32768
    s_mov_b32 s65, 0
    buffer_load_dwordx4 v11, s[48:51], s65 offen lds
    s_add_u32 m0, s89, 33792
    s_mov_b32 s65, 43008
    buffer_load_dwordx4 v11, s[48:51], s65 offen lds
    s_add_u32 m0, s89, 34816
    s_mov_b32 s65, 86016
    buffer_load_dwordx4 v11, s[48:51], s65 offen lds
    s_waitcnt vmcnt(3)
    ds_write_b16 v15, v12
    s_waitcnt vmcnt(0)
    s_mov_b32 exec_hi, 0xffff
    ds_write_b16 v16, v13
    s_mov_b32 exec_hi, -1
    s_waitcnt lgkmcnt(0)
    s_barrier
    s_add_u32 m0, s88, 0
    s_mov_b32 s65, 0
    buffer_load_dwordx4 v10, s[44:47], s65 offen lds
    s_add_u32 m0, s88, 1024
    s_mov_b32 s65, 43008
    buffer_load_dwordx4 v10, s[44:47], s65 offen lds
    s_add_u32 m0, s88, 2048
    s_mov_b32 s65, 86016
    buffer_load_dwordx4 v10, s[44:47], s65 offen lds
    s_add_u32 m0, s88, 3072
    s_mov_b32 s65, 129024
    buffer_load_dwordx4 v10, s[44:47], s65 offen lds
    s_barrier
    s_add_u32 m0, s89, 16384
    s_mov_b32 s65, 0
    buffer_load_dwordx4 v11, s[44:47], s65 offen lds
    s_add_u32 m0, s89, 17408
    s_mov_b32 s65, 43008
    buffer_load_dwordx4 v11, s[44:47], s65 offen lds
    s_add_u32 m0, s89, 18432
    s_mov_b32 s65, 86016
    buffer_load_dwordx4 v11, s[44:47], s65 offen lds
    s_xor_b32 s64, s27, 3
    s_xor_b32 s65, s26, 1
    s_or_b32 s90, s64, s65
    s_barrier
    s_cbranch_scc1 H_NOSIGKV
    s_mov_b32 exec_hi, 0
    v_lshlrev_b32 v20, 2, v0
    v_mov_b32 v19, s87
    buffer_store_dword v19, v20, s[52:55], s66 offen sc1
    s_mov_b32 exec_hi, -1
H_NOSIGKV:
    s_waitcnt vmcnt(4)
    s_cmp_eq_u32 s90, 0
    s_cbranch_scc1 H_W4
    s_waitcnt vmcnt(3)
H_W4:
    s_barrier
    s_waitcnt vmcnt(1)
    s_cbranch_scc1 H_SIGD
    s_waitcnt vmcnt(0)
H_SIGD:
    s_barrier
    v_mov_b32 v1, 145408
    v_mov_b32 v8, 0
    v_mov_b32 v9, 0
    v_mov_b32 v10, 0
    v_mov_b32 v11, 0
    ds_write_b128 v1, v[8:11]
    s_nop 1
    v_mov_b32 v9, s87
    ds_write_b128 v1, v[8:11] offset:16
    v_lshlrev_b32 v2, 4, v0
    v_lshrrev_b32 v4, 4, v0
    v_bfe_u32 v5, v0, 2, 2
    v_and_b32 v3, 1, v4
    v_xor_b32 v5, v5, v3
    v_lshrrev_b32 v3, 1, v5
    v_lshl_add_u32 v4, v4, 1, v3
    v_mul_u32_u24 v4, 896, v4
    v_and_b32 v5, 1, v5
    v_lshl_add_u32 v4, v5, 6, v4
    v_and_b32 v5, 3, v0
    v_lshl_add_u32 v3, v5, 4, v4
    s_mul_i32 s64, s27, 7168
    s_lshl_b32 s65, s31, 7
    s_add_u32 s64, s64, s65
    v_add_u32 v3, s64, v3
    s_lshr_b32 s65, s27, 1
    s_mul_i32 s64, s65, 28672
    s_lshl_b32 s65, s65, 6
    v_mov_b32 v5, 0
    v_bfe_u32 v8, v0, 4, 1
    v_lshl_add_u32 v5, v8, 5, v5
    v_and_b32 v8, 3, v0
    v_lshl_add_u32 v5, v8, 3, v5
    v_bfe_u32 v8, v0, 2, 1
    v_lshrrev_b32 v9, 6, v5
    v_lshl_add_u32 v8, v8, 1, v9
    v_bfe_u32 v9, v0, 3, 1
    v_xor_b32 v8, v8, v9
    v_and_b32 v5, 63, v5
    v_lshl_add_u32 v5, v8, 6, v5
    v_lshrrev_b32 v8, 5, v0
    v_lshl_add_u32 v8, v8, 1, v9
    v_lshl_add_u32 v4, v8, 8, v5
    v_add_u32 v4, s64, v4
    v_xor_b32 v4, s65, v4
    v_xor_b32 v5, 64, v4
    v_lshrrev_b32 v8, 5, v0
    v_lshlrev_b32 v8, 9, v8
    v_sub_u32 v6, v4, v8
    v_sub_u32 v7, v5, v8
    s_mov_b32 s44, s8
    s_mov_b32 s45, s9
    s_mov_b32 s46, 401408
    s_mov_b32 s47, 0x20000
    s_mov_b32 s48, s14
    s_mov_b32 s49, s15
    s_mov_b32 s50, 401408
    s_mov_b32 s51, 0x20000
    s_lshl_b32 s65, s25, 2
    s_add_u32 s65, s65, s27
    s_lshl_b32 s65, s65, 9
    s_add_u32 s65, s65, 5242880
    v_lshlrev_b32 v10, 7, v0
    s_cmp_eq_u32 s27, 0
    s_cbranch_scc0 H_KVD
    s_mov_b64 exec, 65535
    s_mov_b32 s68, 200000
    s_branch POLL_KV
POLLS_KV:
    s_mov_b64 exec, vcc
    s_sleep 6
POLL_KV:
    buffer_load_dword v11, v10, s[52:55], s65 offen sc1
    s_sub_u32 s68, s68, 1
    s_cbranch_scc1 POLLX_KV
    s_waitcnt vmcnt(0)
    v_cmp_ne_u32 vcc, s87, v11
    s_cbranch_vccnz POLLS_KV
POLLX_KV:
    s_mov_b64 exec, -1
H_KVD:
    s_waitcnt lgkmcnt(0)
    s_barrier
    s_setprio 2
    s_mov_b64 exec, 1
    s_mov_b32 s68, 200000
LW_C0:
    s_sleep 1
    ds_read_b32 v9, v1 offset:8
    s_waitcnt lgkmcnt(0)
    v_readfirstlane_b32 s69, v9
    s_sub_u32 s68, s68, 1
    s_cbranch_scc1 LWX_C0
    s_cmp_ge_u32 s69, 4
    s_cbranch_scc0 LW_C0
LWX_C0:
    s_mov_b64 exec, -1
    s_lshl_b32 s64, s27, 11
    s_add_u32 s64, s64, 155648
    v_add_u32 v8, s64, v2
    ds_read_b128 v[80:83], v8
    ds_read_b128 v[84:87], v8 offset:1024
    s_lshl_b32 s64, s27, 8
    s_add_u32 s64, s64, 146432
    v_lshl_add_u32 v8, v0, 2, s64
    ds_read_b32 v88, v8
    s_cmp_ge_u32 s27, 2
    s_cselect_b32 s64, s26, 1
    s_cmp_eq_u32 s64, 0
    s_cbranch_scc0 H_NOKVP
    s_and_b32 s65, s27, 1
    s_lshl_b32 s64, s65, 12
    s_add_u32 s64, s64, 114688
    v_add_u32 v8, s64, v2
    ds_read_b128 v[16:19], v8 offset:0
    ds_read_b128 v[20:23], v8 offset:1024
    ds_read_b128 v[24:27], v8 offset:2048
    ds_read_b128 v[28:31], v8 offset:3072
    ds_read_b128 v[32:35], v8 offset:8192
    ds_read_b128 v[36:39], v8 offset:9216
    ds_read_b128 v[40:43], v8 offset:10240
    ds_read_b128 v[44:47], v8 offset:11264
    s_lshl_b32 s64, s25, 1
    s_add_u32 s64, s64, s65
    s_mul_i32 s64, s64, 69632
    s_lshl_b32 s65, s24, 12
    s_add_u32 s64, s64, s65
    s_add_u32 s64, s64, 6291456
    s_waitcnt lgkmcnt(0)
    v_add_f32 v16, v16, v32
    v_add_f32 v17, v17, v33
    v_add_f32 v18, v18, v34
    v_add_f32 v19, v19, v35
    v_add_f32 v20, v20, v36
    v_add_f32 v21, v21, v37
    v_add_f32 v22, v22, v38
    v_add_f32 v23, v23, v39
    v_add_f32 v24, v24, v40
    v_add_f32 v25, v25, v41
    v_add_f32 v26, v26, v42
    v_add_f32 v27, v27, v43
    v_add_f32 v28, v28, v44
    v_add_f32 v29, v29, v45
    v_add_f32 v30, v30, v46
    v_add_f32 v31, v31, v47
    buffer_store_dwordx4 v[16:19], v2, s[52:55], s64 offen offset:0 sc1
    buffer_store_dwordx4 v[20:23], v2, s[52:55], s64 offen offset:1024 sc1
    buffer_store_dwordx4 v[24:27], v2, s[52:55], s64 offen offset:2048 sc1
    buffer_store_dwordx4 v[28:31], v2, s[52:55], s64 offen offset:3072 sc1
    s_lshl_b32 s64, s25, 4
    s_add_u32 s64, s64, s24
    s_lshl_b32 s64, s64, 7
    s_add_u32 s64, s64, 5259264
    v_mov_b32 v11, 1
    s_waitcnt vmcnt(0)
    s_mov_b64 exec, 1
    ds_add_rtn_u32 v9, v1, v11 offset:12
    s_waitcnt lgkmcnt(0)
    v_readfirstlane_b32 s69, v9
    s_mov_b64 exec, -1
    s_cmp_eq_u32 s69, 1
    s_cbranch_scc0 H_NOKVP
    s_mov_b32 exec_hi, 0
    v_lshlrev_b32 v9, 2, v0
    v_mov_b32 v11, s87
    buffer_store_dword v11, v9, s[52:55], s64 offen sc1
    s_mov_b32 exec_hi, -1
H_NOKVP:
    s_cmp_ge_u32 s32, 28
    s_cbranch_scc1 H_NOWOA
    s_lshl_b32 s66, s27, 10
    s_add_u32 s66, s66, 0
    s_mov_b32 s63, 0
H_WOA:
    s_mov_b32 m0, s66
    s_add_u32 s66, s66, 4096
    buffer_load_dwordx4 v3, s[44:47], s63 offen lds
    s_add_u32 s63, s63, 28672
    s_waitcnt vmcnt(5)
    s_cmp_lt_u32 s63, 401408
    s_cbranch_scc1 H_WOA
    s_lshl_b32 s66, s27, 10
    s_add_u32 s66, s66, 57344
    s_mov_b32 s63, 0
H_WOB:
    s_mov_b32 m0, s66
    s_add_u32 s66, s66, 4096
    buffer_load_dwordx4 v3, s[48:51], s63 offen lds
    s_add_u32 s63, s63, 28672
    s_waitcnt vmcnt(5)
    s_cmp_lt_u32 s63, 401408
    s_cbranch_scc1 H_WOB
H_NOWOA:
    s_lshl_b32 s64, s25, 11
    s_add_u32 s64, s64, 5259264
    s_cmp_eq_u32 s27, 0
    s_cbranch_scc0 H_AW
    s_mov_b64 exec, 65535
    s_mov_b32 s68, 200000
    s_branch POLL_A
POLLS_A:
    s_mov_b64 exec, vcc
    s_sleep 16
POLL_A:
    buffer_load_dword v11, v10, s[52:55], s64 offen sc1
    s_sub_u32 s68, s68, 1
    s_cbranch_scc1 POLLX_A
    s_waitcnt vmcnt(0)
    v_cmp_ne_u32 vcc, s87, v11
    s_cbranch_vccnz POLLS_A
POLLX_A:
    s_mov_b64 exec, -1
    v_mov_b32 v11, 1
    ds_write_b32 v1, v11 offset:16
    s_branch H_AD
H_AW:
    s_mov_b64 exec, 1
    s_mov_b32 s68, 200000
LW_A:
    s_sleep 4
    ds_read_b32 v9, v1 offset:16
    s_waitcnt lgkmcnt(0)
    v_readfirstlane_b32 s69, v9
    s_sub_u32 s68, s68, 1
    s_cbranch_scc1 LWX_A
    s_cmp_ge_u32 s69, 1
    s_cbranch_scc0 LW_A
LWX_A:
    s_mov_b64 exec, -1
H_AD:
    s_mul_i32 s64, s28, 69632
    s_lshl_b32 s65, s27, 10
    s_add_u32 s64, s64, s65
    s_add_u32 s64, s64, 6291456
    buffer_load_dwordx4 v[16:19], v2, s[52:55], s64 offen sc1
    s_add_u32 s64, s64, 4096
    buffer_load_dwordx4 v[20:23], v2, s[52:55], s64 offen sc1
    s_add_u32 s64, s64, 4096
    buffer_load_dwordx4 v[24:27], v2, s[52:55], s64 offen sc1
    s_add_u32 s64, s64, 4096
    s_waitcnt vmcnt(2)
    buffer_load_dwordx4 v[28:31], v2, s[52:55], s64 offen sc1
    s_add_u32 s64, s64, 4096
    s_waitcnt vmcnt(2)
    v_add_f32 v16, v16, v20
    v_add_f32 v17, v17, v21
    v_add_f32 v18, v18, v22
    v_add_f32 v19, v19, v23
    buffer_load_dwordx4 v[32:35], v2, s[52:55], s64 offen sc1
    s_add_u32 s64, s64, 4096
    s_waitcnt vmcnt(2)
    v_add_f32 v16, v16, v24
    v_add_f32 v17, v17, v25
    v_add_f32 v18, v18, v26
    v_add_f32 v19, v19, v27
    buffer_load_dwordx4 v[36:39], v2, s[52:55], s64 offen sc1
    s_add_u32 s64, s64, 4096
    s_waitcnt vmcnt(2)
    v_add_f32 v16, v16, v28
    v_add_f32 v17, v17, v29
    v_add_f32 v18, v18, v30
    v_add_f32 v19, v19, v31
    buffer_load_dwordx4 v[40:43], v2, s[52:55], s64 offen sc1
    s_add_u32 s64, s64, 4096
    s_waitcnt vmcnt(2)
    v_add_f32 v16, v16, v32
    v_add_f32 v17, v17, v33
    v_add_f32 v18, v18, v34
    v_add_f32 v19, v19, v35
    buffer_load_dwordx4 v[44:47], v2, s[52:55], s64 offen sc1
    s_add_u32 s64, s64, 4096
    s_waitcnt vmcnt(2)
    v_add_f32 v16, v16, v36
    v_add_f32 v17, v17, v37
    v_add_f32 v18, v18, v38
    v_add_f32 v19, v19, v39
    buffer_load_dwordx4 v[48:51], v2, s[52:55], s64 offen sc1
    s_add_u32 s64, s64, 4096
    s_waitcnt vmcnt(2)
    v_add_f32 v16, v16, v40
    v_add_f32 v17, v17, v41
    v_add_f32 v18, v18, v42
    v_add_f32 v19, v19, v43
    buffer_load_dwordx4 v[52:55], v2, s[52:55], s64 offen sc1
    s_add_u32 s64, s64, 4096
    s_waitcnt vmcnt(2)
    v_add_f32 v16, v16, v44
    v_add_f32 v17, v17, v45
    v_add_f32 v18, v18, v46
    v_add_f32 v19, v19, v47
    buffer_load_dwordx4 v[56:59], v2, s[52:55], s64 offen sc1
    s_add_u32 s64, s64, 4096
    s_waitcnt vmcnt(2)
    v_add_f32 v16, v16, v48
    v_add_f32 v17, v17, v49
    v_add_f32 v18, v18, v50
    v_add_f32 v19, v19, v51
    buffer_load_dwordx4 v[60:63], v2, s[52:55], s64 offen sc1
    s_add_u32 s64, s64, 4096
    s_waitcnt vmcnt(2)
    v_add_f32 v16, v16, v52
    v_add_f32 v17, v17, v53
    v_add_f32 v18, v18, v54
    v_add_f32 v19, v19, v55
    buffer_load_dwordx4 v[64:67], v2, s[52:55], s64 offen sc1
    s_add_u32 s64, s64, 4096
    s_waitcnt vmcnt(2)
    v_add_f32 v16, v16, v56
    v_add_f32 v17, v17, v57
    v_add_f32 v18, v18, v58
    v_add_f32 v19, v19, v59
    buffer_load_dwordx4 v[68:71], v2, s[52:55], s64 offen sc1
    s_add_u32 s64, s64, 4096
    s_waitcnt vmcnt(2)
    v_add_f32 v16, v16, v60
    v_add_f32 v17, v17, v61
    v_add_f32 v18, v18, v62
    v_add_f32 v19, v19, v63
    buffer_load_dwordx4 v[72:75], v2, s[52:55], s64 offen sc1
    s_add_u32 s64, s64, 4096
    s_waitcnt vmcnt(2)
    v_add_f32 v16, v16, v64
    v_add_f32 v17, v17, v65
    v_add_f32 v18, v18, v66
    v_add_f32 v19, v19, v67
    buffer_load_dwordx4 v[76:79], v2, s[52:55], s64 offen sc1
    s_add_u32 s64, s64, 4096
    s_waitcnt vmcnt(2)
    v_add_f32 v16, v16, v68
    v_add_f32 v17, v17, v69
    v_add_f32 v18, v18, v70
    v_add_f32 v19, v19, v71
    s_waitcnt vmcnt(1)
    v_add_f32 v16, v16, v72
    v_add_f32 v17, v17, v73
    v_add_f32 v18, v18, v74
    v_add_f32 v19, v19, v75
    s_waitcnt vmcnt(0)
    v_add_f32 v16, v16, v76
    v_add_f32 v17, v17, v77
    v_add_f32 v18, v18, v78
    v_add_f32 v19, v19, v79
    v_cvt_pk_bf16_f32 v16, v16, v17
    v_cvt_pk_bf16_f32 v17, v18, v19
    s_lshr_b32 s64, s27, 1
    s_lshl_b32 s64, s64, 10
    s_and_b32 s65, s27, 1
    s_lshl_b32 s65, s65, 3
    s_add_u32 s64, s64, s65
    s_add_u32 s64, s64, 143360
    v_add_u32 v8, s64, v2
    ds_write_b64 v8, v[16:17]
    v_mov_b32 v11, 1
    s_waitcnt lgkmcnt(0)
    s_mov_b64 exec, 1
    ds_add_u32 v1, v11
    s_mov_b64 exec, 1
    s_mov_b32 s68, 200000
LW_C1:
    s_sleep 1
    ds_read_b32 v9, v1 offset:0
    s_waitcnt lgkmcnt(0)
    v_readfirstlane_b32 s69, v9
    s_sub_u32 s68, s68, 1
    s_cbranch_scc1 LWX_C1
    s_cmp_ge_u32 s69, 4
    s_cbranch_scc0 LW_C1
LWX_C1:
    s_mov_b64 exec, -1
    v_add_u32 v8, 143360, v2
    ds_read_b128 v[92:95], v8
    ds_read_b128 v[96:99], v8 offset:1024
    s_waitcnt lgkmcnt(0)
    v_mfma_f32_32x32x16_bf16 v[100:115], v[92:95], v[80:83], 0
    v_mfma_f32_32x32x16_bf16 v[100:115], v[96:99], v[84:87], v[100:115]
    s_lshl_b32 s64, s24, 2
    s_add_u32 s64, s64, s27
    s_mul_i32 s64, s64, 69632
    s_lshl_b32 s65, s28, 11
    s_add_u32 s64, s64, s65
    s_add_u32 s64, s64, 8388608
    v_mov_b32 v122, 0
    v_mov_b32 v123, 0
    s_nop 15
    v_mov_b32 v8, v112
    v_mov_b32 v9, v112
    s_nop 1
    v_permlane32_swap_b32 v8, v9
    v_add_f32 v9, 0x358637bd, v9
    v_rcp_f32 v9, v9
    s_nop 0
    v_mul_f32 v9, v9, v88
    v_mul_f32 v100, v9, v100
    v_mul_f32 v101, v9, v101
    v_mul_f32 v102, v9, v102
    v_mul_f32 v103, v9, v103
    v_mul_f32 v104, v9, v104
    v_mul_f32 v105, v9, v105
    v_mul_f32 v106, v9, v106
    v_mul_f32 v107, v9, v107
    v_mul_f32 v108, v9, v108
    v_mul_f32 v109, v9, v109
    v_mul_f32 v110, v9, v110
    v_mul_f32 v111, v9, v111
    v_mul_f32 v112, v9, v112
    v_mul_f32 v113, v9, v113
    v_mul_f32 v114, v9, v114
    v_mul_f32 v115, v9, v115
    v_cvt_pk_bf16_f32 v116, v100, v101
    v_cvt_pk_bf16_f32 v117, v102, v103
    v_cvt_pk_bf16_f32 v118, v104, v105
    v_cvt_pk_bf16_f32 v119, v106, v107
    v_cvt_pk_bf16_f32 v120, v108, v109
    v_cvt_pk_bf16_f32 v121, v110, v111
    s_mov_b32 exec_hi, 0
    v_cvt_pk_bf16_f32 v122, v112, v113
    v_cvt_pk_bf16_f32 v123, v114, v115
    s_mov_b32 exec_hi, -1
    buffer_store_dwordx4 v[116:119], v2, s[52:55], s64 offen sc1
    buffer_store_dwordx4 v[120:123], v2, s[52:55], s64 offen offset:1024 sc1
    s_waitcnt vmcnt(0)
    s_mov_b64 exec, 1
    ds_add_rtn_u32 v9, v1, v11 offset:4
    s_waitcnt lgkmcnt(0)
    v_readfirstlane_b32 s69, v9
    s_mov_b64 exec, -1
    s_cmp_eq_u32 s69, 3
    s_cbranch_scc0 H_NOSIGOA
    s_lshl_b32 s64, s24, 4
    s_add_u32 s64, s64, s28
    s_lshl_b32 s64, s64, 7
    s_add_u32 s64, s64, 5275648
    s_mov_b32 exec_hi, 0
    v_lshlrev_b32 v9, 2, v0
    v_mov_b32 v11, s87
    buffer_store_dword v11, v9, s[52:55], s64 offen sc1
    s_mov_b32 exec_hi, -1
H_NOSIGOA:
    s_setprio 0
    s_barrier
    s_cmp_ge_u32 s32, 28
    s_cbranch_scc1 H_NOP3B
    s_and_b32 s64, s30, 0xfe
    s_lshr_b32 s65, s27, 1
    s_add_u32 s64, s64, s65
    s_lshl_b32 s64, s64, 10
    s_add_u32 s64, s64, 5275648
    s_and_b32 s62, s27, 1
    s_lshl_b32 s65, s30, 1
    s_add_u32 s62, s62, s65
    s_mul_i32 s62, s62, 69632
    s_lshr_b32 s65, s27, 1
    s_lshl_b32 s65, s65, 14
    s_add_u32 s62, s62, s65
    s_add_u32 s62, s62, 8388608
    s_mov_b64 exec, 0xff
    buffer_load_dword v11, v10, s[52:55], s64 offen sc1
    s_waitcnt vmcnt(0)
    v_cmp_ne_u32 vcc, s87, v11
    s_mov_b64 exec, -1
    s_cbranch_vccnz H_OALATE
    buffer_load_dwordx4 a[0:3], v2, s[52:55], s62 offen offset:0 sc1
    buffer_load_dwordx4 a[4:7], v2, s[52:55], s62 offen offset:1024 sc1
    buffer_load_dwordx4 a[8:11], v2, s[52:55], s62 offen offset:2048 sc1
    buffer_load_dwordx4 a[12:15], v2, s[52:55], s62 offen offset:3072 sc1
    s_add_u32 s62, s62, 4096
    buffer_load_dwordx4 a[16:19], v2, s[52:55], s62 offen offset:0 sc1
    buffer_load_dwordx4 a[20:23], v2, s[52:55], s62 offen offset:1024 sc1
    buffer_load_dwordx4 a[24:27], v2, s[52:55], s62 offen offset:2048 sc1
    buffer_load_dwordx4 a[28:31], v2, s[52:55], s62 offen offset:3072 sc1
    s_add_u32 s62, s62, 4096
    buffer_load_dwordx4 a[32:35], v2, s[52:55], s62 offen offset:0 sc1
    buffer_load_dwordx4 a[36:39], v2, s[52:55], s62 offen offset:1024 sc1
    buffer_load_dwordx4 a[40:43], v2, s[52:55], s62 offen offset:2048 sc1
    buffer_load_dwordx4 a[44:47], v2, s[52:55], s62 offen offset:3072 sc1
    s_add_u32 s62, s62, 4096
    buffer_load_dwordx4 a[48:51], v2, s[52:55], s62 offen offset:0 sc1
    buffer_load_dwordx4 a[52:55], v2, s[52:55], s62 offen offset:1024 sc1
    buffer_load_dwordx4 a[56:59], v2, s[52:55], s62 offen offset:2048 sc1
    buffer_load_dwordx4 a[60:63], v2, s[52:55], s62 offen offset:3072 sc1
    s_barrier
    s_barrier
    s_branch H_OADONE
H_OALATE:
    s_barrier
    s_barrier
    s_mov_b64 exec, 255
    s_mov_b32 s68, 200000
    s_branch POLL_OA
POLLS_OA:
    s_mov_b64 exec, vcc
    s_sleep 2
POLL_OA:
    buffer_load_dword v11, v10, s[52:55], s64 offen sc1
    s_sub_u32 s68, s68, 1
    s_cbranch_scc1 POLLX_OA
    s_waitcnt vmcnt(0)
    v_cmp_ne_u32 vcc, s87, v11
    s_cbranch_vccnz POLLS_OA
POLLX_OA:
    s_mov_b64 exec, -1
    buffer_load_dwordx4 a[0:3], v2, s[52:55], s62 offen offset:0 sc1
    buffer_load_dwordx4 a[4:7], v2, s[52:55], s62 offen offset:1024 sc1
    buffer_load_dwordx4 a[8:11], v2, s[52:55], s62 offen offset:2048 sc1
    buffer_load_dwordx4 a[12:15], v2, s[52:55], s62 offen offset:3072 sc1
    s_add_u32 s62, s62, 4096
    buffer_load_dwordx4 a[16:19], v2, s[52:55], s62 offen offset:0 sc1
    buffer_load_dwordx4 a[20:23], v2, s[52:55], s62 offen offset:1024 sc1
    buffer_load_dwordx4 a[24:27], v2, s[52:55], s62 offen offset:2048 sc1
    buffer_load_dwordx4 a[28:31], v2, s[52:55], s62 offen offset:3072 sc1
    s_add_u32 s62, s62, 4096
    buffer_load_dwordx4 a[32:35], v2, s[52:55], s62 offen offset:0 sc1
    buffer_load_dwordx4 a[36:39], v2, s[52:55], s62 offen offset:1024 sc1
    buffer_load_dwordx4 a[40:43], v2, s[52:55], s62 offen offset:2048 sc1
    buffer_load_dwordx4 a[44:47], v2, s[52:55], s62 offen offset:3072 sc1
    s_add_u32 s62, s62, 4096
    buffer_load_dwordx4 a[48:51], v2, s[52:55], s62 offen offset:0 sc1
    buffer_load_dwordx4 a[52:55], v2, s[52:55], s62 offen offset:1024 sc1
    buffer_load_dwordx4 a[56:59], v2, s[52:55], s62 offen offset:2048 sc1
    buffer_load_dwordx4 a[60:63], v2, s[52:55], s62 offen offset:3072 sc1
H_OADONE:
    ds_read_b64_tr_b16 v[48:49], v4 offset:0
    ds_read_b64_tr_b16 v[50:51], v4 offset:1024
    ds_read_b64_tr_b16 v[52:53], v5 offset:0
    ds_read_b64_tr_b16 v[54:55], v5 offset:1024
    s_waitcnt vmcnt(15) lgkmcnt(2)
    v_mfma_f32_32x32x16_bf16 v[16:31], v[48:51], a[0:3], 0
    ds_read_b64_tr_b16 v[56:57], v4 offset:2048
    ds_read_b64_tr_b16 v[58:59], v4 offset:3072
    s_waitcnt lgkmcnt(2)
    v_mfma_f32_32x32x16_bf16 v[32:47], v[52:55], a[0:3], 0
    ds_read_b64_tr_b16 v[60:61], v5 offset:2048
    ds_read_b64_tr_b16 v[62:63], v5 offset:3072
    s_waitcnt vmcnt(14) lgkmcnt(2)
    v_mfma_f32_32x32x16_bf16 v[16:31], v[56:59], a[4:7], v[16:31]
    ds_read_b64_tr_b16 v[48:49], v4 offset:3584
    ds_read_b64_tr_b16 v[50:51], v4 offset:4608
    s_waitcnt lgkmcnt(2)
    v_mfma_f32_32x32x16_bf16 v[32:47], v[60:63], a[4:7], v[32:47]
    ds_read_b64_tr_b16 v[52:53], v5 offset:3584
    ds_read_b64_tr_b16 v[54:55], v5 offset:4608
    s_waitcnt vmcnt(13) lgkmcnt(2)
    v_mfma_f32_32x32x16_bf16 v[16:31], v[48:51], a[8:11], v[16:31]
    ds_read_b64_tr_b16 v[56:57], v4 offset:5632
    ds_read_b64_tr_b16 v[58:59], v4 offset:6656
    s_waitcnt lgkmcnt(2)
    v_mfma_f32_32x32x16_bf16 v[32:47], v[52:55], a[8:11], v[32:47]
    ds_read_b64_tr_b16 v[60:61], v5 offset:5632
    ds_read_b64_tr_b16 v[62:63], v5 offset:6656
    s_waitcnt vmcnt(12) lgkmcnt(2)
    v_mfma_f32_32x32x16_bf16 v[16:31], v[56:59], a[12:15], v[16:31]
    ds_read_b64_tr_b16 v[48:49], v4 offset:7168
    ds_read_b64_tr_b16 v[50:51], v4 offset:8192
    s_waitcnt lgkmcnt(2)
    v_mfma_f32_32x32x16_bf16 v[32:47], v[60:63], a[12:15], v[32:47]
    ds_read_b64_tr_b16 v[52:53], v5 offset:7168
    ds_read_b64_tr_b16 v[54:55], v5 offset:8192
    s_waitcnt vmcnt(11) lgkmcnt(2)
    v_mfma_f32_32x32x16_bf16 v[16:31], v[48:51], a[16:19], v[16:31]
    ds_read_b64_tr_b16 v[56:57], v4 offset:9216
    ds_read_b64_tr_b16 v[58:59], v4 offset:10240
    s_waitcnt lgkmcnt(2)
    v_mfma_f32_32x32x16_bf16 v[32:47], v[52:55], a[16:19], v[32:47]
    ds_read_b64_tr_b16 v[60:61], v5 offset:9216
    ds_read_b64_tr_b16 v[62:63], v5 offset:10240
    s_waitcnt vmcnt(10) lgkmcnt(2)
    v_mfma_f32_32x32x16_bf16 v[16:31], v[56:59], a[20:23], v[16:31]
    ds_read_b64_tr_b16 v[48:49], v4 offset:10752
    ds_read_b64_tr_b16 v[50:51], v4 offset:11776
    s_waitcnt lgkmcnt(2)
    v_mfma_f32_32x32x16_bf16 v[32:47], v[60:63], a[20:23], v[32:47]
    ds_read_b64_tr_b16 v[52:53], v5 offset:10752
    ds_read_b64_tr_b16 v[54:55], v5 offset:11776
    s_waitcnt vmcnt(9) lgkmcnt(2)
    v_mfma_f32_32x32x16_bf16 v[16:31], v[48:51], a[24:27], v[16:31]
    ds_read_b64_tr_b16 v[56:57], v4 offset:12800
    ds_read_b64_tr_b16 v[58:59], v4 offset:13824
    s_waitcnt lgkmcnt(2)
    v_mfma_f32_32x32x16_bf16 v[32:47], v[52:55], a[24:27], v[32:47]
    ds_read_b64_tr_b16 v[60:61], v5 offset:12800
    ds_read_b64_tr_b16 v[62:63], v5 offset:13824
    s_waitcnt vmcnt(8) lgkmcnt(2)
    v_mfma_f32_32x32x16_bf16 v[16:31], v[56:59], a[28:31], v[16:31]
    ds_read_b64_tr_b16 v[48:49], v4 offset:14336
    ds_read_b64_tr_b16 v[50:51], v4 offset:15360
    s_waitcnt lgkmcnt(2)
    v_mfma_f32_32x32x16_bf16 v[32:47], v[60:63], a[28:31], v[32:47]
    ds_read_b64_tr_b16 v[52:53], v5 offset:14336
    ds_read_b64_tr_b16 v[54:55], v5 offset:15360
    s_waitcnt vmcnt(7) lgkmcnt(2)
    v_mfma_f32_32x32x16_bf16 v[16:31], v[48:51], a[32:35], v[16:31]
    ds_read_b64_tr_b16 v[56:57], v4 offset:16384
    ds_read_b64_tr_b16 v[58:59], v4 offset:17408
    s_waitcnt lgkmcnt(2)
    v_mfma_f32_32x32x16_bf16 v[32:47], v[52:55], a[32:35], v[32:47]
    ds_read_b64_tr_b16 v[60:61], v5 offset:16384
    ds_read_b64_tr_b16 v[62:63], v5 offset:17408
    s_waitcnt vmcnt(6) lgkmcnt(2)
    v_mfma_f32_32x32x16_bf16 v[16:31], v[56:59], a[36:39], v[16:31]
    ds_read_b64_tr_b16 v[48:49], v4 offset:17920
    ds_read_b64_tr_b16 v[50:51], v4 offset:18944
    s_waitcnt lgkmcnt(2)
    v_mfma_f32_32x32x16_bf16 v[32:47], v[60:63], a[36:39], v[32:47]
    ds_read_b64_tr_b16 v[52:53], v5 offset:17920
    ds_read_b64_tr_b16 v[54:55], v5 offset:18944
    s_waitcnt vmcnt(5) lgkmcnt(2)
    v_mfma_f32_32x32x16_bf16 v[16:31], v[48:51], a[40:43], v[16:31]
    ds_read_b64_tr_b16 v[56:57], v4 offset:19968
    ds_read_b64_tr_b16 v[58:59], v4 offset:20992
    s_waitcnt lgkmcnt(2)
    v_mfma_f32_32x32x16_bf16 v[32:47], v[52:55], a[40:43], v[32:47]
    ds_read_b64_tr_b16 v[60:61], v5 offset:19968
    ds_read_b64_tr_b16 v[62:63], v5 offset:20992
    s_waitcnt vmcnt(4) lgkmcnt(2)
    v_mfma_f32_32x32x16_bf16 v[16:31], v[56:59], a[44:47], v[16:31]
    ds_read_b64_tr_b16 v[48:49], v4 offset:21504
    ds_read_b64_tr_b16 v[50:51], v4 offset:22528
    s_waitcnt lgkmcnt(2)
    v_mfma_f32_32x32x16_bf16 v[32:47], v[60:63], a[44:47], v[32:47]
    ds_read_b64_tr_b16 v[52:53], v5 offset:21504
    ds_read_b64_tr_b16 v[54:55], v5 offset:22528
    s_waitcnt vmcnt(3) lgkmcnt(2)
    v_mfma_f32_32x32x16_bf16 v[16:31], v[48:51], a[48:51], v[16:31]
    ds_read_b64_tr_b16 v[56:57], v4 offset:23552
    ds_read_b64_tr_b16 v[58:59], v4 offset:24576
    s_waitcnt lgkmcnt(2)
    v_mfma_f32_32x32x16_bf16 v[32:47], v[52:55], a[48:51], v[32:47]
    ds_read_b64_tr_b16 v[60:61], v5 offset:23552
    ds_read_b64_tr_b16 v[62:63], v5 offset:24576
    s_waitcnt vmcnt(2) lgkmcnt(2)
    v_mfma_f32_32x32x16_bf16 v[16:31], v[56:59], a[52:55], v[16:31]
    ds_read_b64_tr_b16 v[48:49], v4 offset:25088
    ds_read_b64_tr_b16 v[50:51], v4 offset:26112
    s_waitcnt lgkmcnt(2)
    v_mfma_f32_32x32x16_bf16 v[32:47], v[60:63], a[52:55], v[32:47]
    ds_read_b64_tr_b16 v[52:53], v5 offset:25088
    ds_read_b64_tr_b16 v[54:55], v5 offset:26112
    s_waitcnt vmcnt(1) lgkmcnt(2)
    v_mfma_f32_32x32x16_bf16 v[16:31], v[48:51], a[56:59], v[16:31]
    ds_read_b64_tr_b16 v[56:57], v4 offset:27136
    ds_read_b64_tr_b16 v[58:59], v6 offset:28160
    s_waitcnt lgkmcnt(2)
    v_mfma_f32_32x32x16_bf16 v[32:47], v[52:55], a[56:59], v[32:47]
    ds_read_b64_tr_b16 v[60:61], v5 offset:27136
    ds_read_b64_tr_b16 v[62:63], v7 offset:28160
    s_waitcnt vmcnt(0) lgkmcnt(2)
    v_mfma_f32_32x32x16_bf16 v[16:31], v[56:59], a[60:63], v[16:31]
    s_waitcnt lgkmcnt(0)
    v_mfma_f32_32x32x16_bf16 v[32:47], v[60:63], a[60:63], v[32:47]
    s_lshl_b32 s64, s27, 13
    s_add_u32 s64, s64, 114688
    v_add_u32 v8, s64, v2
    s_nop 9
    ds_write_b128 v8, v[16:19] offset:0
    ds_write_b128 v8, v[20:23] offset:1024
    ds_write_b128 v8, v[24:27] offset:2048
    ds_write_b128 v8, v[28:31] offset:3072
    ds_write_b128 v8, v[32:35] offset:4096
    ds_write_b128 v8, v[36:39] offset:5120
    ds_write_b128 v8, v[40:43] offset:6144
    ds_write_b128 v8, v[44:47] offset:7168
    s_waitcnt lgkmcnt(0)
    s_barrier
    s_branch H_EXIT
H_NOP3B:
    s_barrier
    s_barrier
H_EXIT:
    s_endpgm
L_COMPUTE:
    s_lshr_b32 s32, s2, 3
    s_lshr_b32 s33, s25, 2
    s_lshr_b32 s34, s24, 2
    s_and_b32 s29, s24, 3
    s_lshl_b32 s28, s25, 1
    s_cmp_eq_u32 s26, s33
    s_addc_u32 s28, s28, 0
    s_mul_i32 s30, s32, 37
    s_lshr_b32 s30, s30, 8
    s_mul_i32 s31, s30, 7
    s_sub_u32 s31, s32, s31
    s_and_b32 s64, s2, 7
    s_lshl_b32 s64, s64, 2
    s_add_u32 s30, s30, s64
    s_waitcnt lgkmcnt(0)
    s_cmp_ge_u32 s27, 1
    s_cbranch_scc1 C_NTW
    s_cmp_ge_u32 s32, 16
    s_cselect_b32 s40, s12, s6
    s_cselect_b32 s41, s13, s7
    s_mov_b32 s42, 1204224
    s_mov_b32 s43, 0x20000
    s_and_b32 s60, s32, 15
    s_mul_i32 s60, s60, 28
    v_lshrrev_b32 v17, 1, v0
    v_add_u32 v17, s60, v17
    v_mul_u32_u24 v17, 2688, v17
    v_and_b32 v16, 1, v0
    v_lshl_add_u32 v17, v16, 7, v17
    s_mul_i32 s60, s25, 112
    s_and_b32 s60, s60, 0xff80
    s_mul_i32 s61, s27, 896
    s_add_u32 s60, s60, s61
    s_mov_b32 exec_hi, 0xffffff
    buffer_load_dword a88, v17, s[40:43], s60 offen
    s_mov_b64 exec, -1
C_NTW:
    s_mov_b32 s52, s22
    s_mov_b32 s53, s23
    s_mov_b32 s54, 16777216
    s_mov_b32 s55, 0x20000
    s_xor_b32 s64, s27, 3
    s_xor_b32 s65, s2, 8
    s_or_b32 s64, s65, s64
    s_cmp_eq_u32 s64, 0
    s_cbranch_scc0 C_NOINIT
    s_memrealtime s[64:65]
    s_mov_b32 s56, s20
    s_mov_b32 s57, s21
    s_mov_b32 s58, 256
    s_mov_b32 s59, 0x20000
    v_mov_b32 v21, 0
    s_waitcnt lgkmcnt(0)
    s_lshl_b32 s64, s64, 1
    s_or_b32 s64, s64, 1
    v_mov_b32 v22, s64
    s_mov_b64 exec, 1
    buffer_store_dword v22, v21, s[56:59], 0 offen sc1
    s_mov_b64 exec, -1
C_NOINIT:
    s_lshr_b32 s92, s27, 1
    s_and_b32 s93, s27, 1
    v_and_b32 v13, 31, v0
    v_lshrrev_b32 v14, 5, v0
    v_bfe_u32 v15, v0, 1, 3
    v_xor_b32 v15, v15, v14
    s_lshl_b32 s64, s92, 13
    v_lshl_add_u32 v1, v13, 7, s64
    s_lshl_b32 s65, s27, 12
    s_sub_u32 s65, s65, s64
    v_xor_b32 v2, 0, v15
    v_lshl_add_u32 v2, v2, 4, v1
    v_add_u32 v8, s65, v2
    v_xor_b32 v3, 2, v15
    v_lshl_add_u32 v3, v3, 4, v1
    v_add_u32 v9, s65, v3
    v_xor_b32 v4, 4, v15
    v_lshl_add_u32 v4, v4, 4, v1
    v_add_u32 v10, s65, v4
    v_xor_b32 v5, 6, v15
    v_lshl_add_u32 v5, v5, 4, v1
    v_add_u32 v11, s65, v5
    s_mul_i32 s64, s93, 56
    v_mov_b32 v6, s64
    v_bfe_u32 v1, v0, 4, 1
    v_lshl_add_u32 v6, v1, 5, v6
    v_and_b32 v1, 3, v0
    v_lshl_add_u32 v6, v1, 3, v6
    v_bfe_u32 v1, v0, 2, 1
    v_lshrrev_b32 v15, 6, v6
    v_lshl_add_u32 v1, v1, 1, v15
    v_bfe_u32 v15, v0, 3, 1
    v_xor_b32 v1, v1, v15
    v_and_b32 v6, 63, v6
    v_lshl_add_u32 v6, v1, 6, v6
    v_lshrrev_b32 v1, 5, v0
    v_lshl_add_u32 v1, v1, 2, v15
    v_lshl_add_u32 v7, v1, 8, v6
    v_add_u32 v7, 114688, v7
    v_mov_b32 v6, v7
    v_bfe_u32 v1, v0, 2, 2
    v_lshl_add_u32 v1, v14, 3, v1
    v_lshlrev_b32 v1, 1, v1
    v_bfe_u32 v15, v0, 4, 1
    v_add_u32 v1, v1, v15
    v_lshlrev_b32 v1, 2, v1
    v_and_b32 v15, 3, v0
    v_add_u32 v1, v1, v15
    v_lshlrev_b32 v1, 3, v1
    v_add_u32 v12, 114688, v1
    v_cmp_eq_u32 vcc, 28, v13
    v_mov_b32 v1, 1065369472
    s_nop 0
    v_cndmask_b32 v15, 0, v1, vcc
    v_mov_b32 v144, v15
    v_mov_b32 v145, v15
    v_mov_b32 v146, v15
    v_mov_b32 v147, v15
    v_mov_b32 v148, v15
    v_mov_b32 v149, v15
    v_mov_b32 v150, v15
    v_mov_b32 v151, v15
    v_mov_b32 v152, v15
    v_mov_b32 v153, v15
    v_mov_b32 v154, v15
    v_mov_b32 v155, v15
    v_mov_b32 v156, v15
    v_mov_b32 v157, v15
    v_mov_b32 v158, v15
    v_mov_b32 v159, v15
    s_mov_b32 s56, 0x0fffffff
    s_mov_b32 s57, 0x0fffffff
    s_mov_b32 s64, 0x3fb8aa3b
    s_mov_b32 s65, 0x3e8b97f6
    s_mov_b32 s66, 0x358637bd
    v_mov_b32 v96, 0
    v_mov_b32 v97, 0
    v_mov_b32 v98, 0
    v_mov_b32 v99, 0
    v_mov_b32 v100, 0
    v_mov_b32 v101, 0
    v_mov_b32 v102, 0
    v_mov_b32 v103, 0
    v_mov_b32 v104, 0
    v_mov_b32 v105, 0
    v_mov_b32 v106, 0
    v_mov_b32 v107, 0
    v_mov_b32 v108, 0
    v_mov_b32 v109, 0
    v_mov_b32 v110, 0
    v_mov_b32 v111, 0
    v_mov_b32 v112, 0
    v_mov_b32 v113, 0
    v_mov_b32 v114, 0
    v_mov_b32 v115, 0
    v_mov_b32 v116, 0
    v_mov_b32 v117, 0
    v_mov_b32 v118, 0
    v_mov_b32 v119, 0
    v_mov_b32 v120, 0
    v_mov_b32 v121, 0
    v_mov_b32 v122, 0
    v_mov_b32 v123, 0
    v_mov_b32 v124, 0
    v_mov_b32 v125, 0
    v_mov_b32 v126, 0
    v_mov_b32 v127, 0
    v_lshlrev_b32 v13, 4, v0
    s_cmp_eq_u32 s26, 0
    s_cbranch_scc1 C_A
    v_mov_b32 v64, 0
    v_mov_b32 v65, 0
    v_mov_b32 v66, 0
    v_mov_b32 v67, 0
    v_mov_b32 v68, 0
    v_mov_b32 v69, 0
    v_mov_b32 v70, 0
    v_mov_b32 v71, 0
    v_mov_b32 v72, 0
    v_mov_b32 v73, 0
    v_mov_b32 v74, 0
    v_mov_b32 v75, 0
    v_mov_b32 v76, 0
    v_mov_b32 v77, 0
    v_mov_b32 v78, 0
    v_mov_b32 v79, 0
    v_mov_b32 v80, 0
    v_mov_b32 v81, 0
    v_mov_b32 v82, 0
    v_mov_b32 v83, 0
    v_mov_b32 v84, 0
    v_mov_b32 v85, 0
    v_mov_b32 v86, 0
    v_mov_b32 v87, 0
    v_mov_b32 v88, 0
    v_mov_b32 v89, 0
    v_mov_b32 v90, 0
    v_mov_b32 v91, 0
    v_mov_b32 v92, 0
    v_mov_b32 v93, 0
    v_mov_b32 v94, 0
    v_mov_b32 v95, 0
    v_mov_b32 v134, v1
    v_mov_b32 v135, v1
    v_mov_b32 v142, v1
    v_mov_b32 v143, v1
    v_and_b32 v15, 0x33, v0
    v_bfe_u32 v1, v0, 2, 1
    v_lshl_add_u32 v15, v1, 3, v15
    v_bfe_u32 v1, v0, 3, 1
    v_lshl_add_u32 v15, v1, 2, v15
    v_lshlrev_b32 v15, 4, v15
    s_lshl_b32 s58, s25, 1
    s_add_u32 s58, s58, s93
    s_lshl_b32 s58, s58, 2
    s_add_u32 s58, s58, s34
    s_mul_i32 s58, s58, 69632
    s_lshl_b32 s59, s29, 1
    s_add_u32 s59, s59, s92
    s_lshl_b32 s59, s59, 13
    s_add_u32 s58, s58, s59
    s_add_u32 s59, s58, 4096
    s_add_u32 s60, s27, 1
    s_and_b32 s60, s60, 3
    s_lshl_b32 s36, s60, 11
    s_add_u32 s36, s36, 147456
    s_mul_i32 s40, s60, 12288
    s_add_u32 s40, s40, 114688
    s_add_u32 s60, s27, 2
    s_and_b32 s60, s60, 3
    s_lshl_b32 s37, s60, 11
    s_add_u32 s37, s37, 147456
    s_mul_i32 s41, s60, 12288
    s_add_u32 s41, s41, 118784
    s_add_u32 s60, s27, 3
    s_and_b32 s60, s60, 3
    s_lshl_b32 s38, s60, 11
    s_add_u32 s38, s38, 147456
    s_mul_i32 s42, s60, 12288
    s_add_u32 s42, s42, 122880
    s_add_u32 s60, s27, 4
    s_and_b32 s60, s60, 3
    s_lshl_b32 s39, s60, 11
    s_add_u32 s39, s39, 147456
    s_mul_i32 s43, s60, 12288
    s_add_u32 s43, s43, 114688
    s_mul_i32 s44, s28, 278528
    s_mul_i32 s45, s27, 69632
    s_add_u32 s45, s45, s44
    s_lshl_b32 s46, s24, 2
    s_add_u32 s46, s46, s27
    s_mul_i32 s46, s46, 69632
    s_lshl_b32 s60, s28, 11
    s_add_u32 s46, s46, s60
    s_add_u32 s46, s46, 8421376
    s_lshl_b32 s47, s27, 12
    s_add_u32 s47, s47, 114688
    s_lshl_b32 s48, s27, 8
    s_add_u32 s48, s48, 146432
    s_mov_b32 s60, 0
    s_mov_b32 s61, 0
    s_mov_b32 s49, 16384
    s_lshl_b32 s62, s91, 14
    v_add_u32 v2, s62, v2
    v_add_u32 v3, s62, v3
    v_add_u32 v4, s62, v4
    v_add_u32 v5, s62, v5
    s_cmp_eq_u32 s91, 6
    s_cselect_b32 s62, 0xfffe8000, s49
    s_barrier
    ds_read_b128 v[16:19], v2
    ds_read_b64_tr_b16 v[24:25], v6 offset:8192
    ds_read_b64_tr_b16 v[26:27], v6 offset:8704
    ds_read_b128 v[20:23], v2 offset:4096
    ds_read_b64_tr_b16 v[28:29], v6 offset:0
    ds_read_b64_tr_b16 v[30:31], v6 offset:512
.p2align 6
C_B_LOOP:
    s_waitcnt lgkmcnt(3)
    v_mfma_f32_32x32x16_bf16 v[96:111], v[16:19], v[24:27], v[96:111]
    ds_read_b128 v[32:35], v3
    ds_read_b64_tr_b16 v[40:41], v6 offset:10240
    ds_read_b64_tr_b16 v[42:43], v6 offset:10752
    s_waitcnt lgkmcnt(5)
    v_mfma_f32_32x32x16_bf16 v[112:127], v[20:23], v[24:27], v[112:127]
    ds_read_b128 v[36:39], v3 offset:4096
    ds_read_b64_tr_b16 v[44:45], v6 offset:2048
    ds_read_b64_tr_b16 v[46:47], v6 offset:2560
    s_waitcnt lgkmcnt(6)
    v_mfma_f32_32x32x16_bf16 v[64:79], v[28:31], v[16:19], v[64:79]
    v_add_u32 v2, s62, v2
    v_mfma_f32_32x32x16_bf16 v[80:95], v[28:31], v[20:23], v[80:95]
    s_waitcnt lgkmcnt(3)
    v_mfma_f32_32x32x16_bf16 v[96:111], v[32:35], v[40:43], v[96:111]
    ds_read_b128 v[16:19], v4
    ds_read_b64_tr_b16 v[24:25], v6 offset:12288
    ds_read_b64_tr_b16 v[26:27], v6 offset:12800
    s_waitcnt lgkmcnt(5)
    v_mfma_f32_32x32x16_bf16 v[112:127], v[36:39], v[40:43], v[112:127]
    ds_read_b128 v[20:23], v4 offset:4096
    ds_read_b64_tr_b16 v[28:29], v6 offset:4096
    ds_read_b64_tr_b16 v[30:31], v6 offset:4608
    s_waitcnt lgkmcnt(6)
    v_mfma_f32_32x32x16_bf16 v[64:79], v[44:47], v[32:35], v[64:79]
    v_add_u32 v3, s62, v3
    v_mfma_f32_32x32x16_bf16 v[80:95], v[44:47], v[36:39], v[80:95]
    s_waitcnt lgkmcnt(3)
    v_mfma_f32_32x32x16_bf16 v[96:111], v[16:19], v[24:27], v[96:111]
    ds_read_b128 v[32:35], v5
    ds_read_b64_tr_b16 v[40:41], v6 offset:14336
    ds_read_b64_tr_b16 v[42:43], v6 offset:14848
    s_waitcnt lgkmcnt(5)
    v_mfma_f32_32x32x16_bf16 v[112:127], v[20:23], v[24:27], v[112:127]
    ds_read_b128 v[36:39], v5 offset:4096
    ds_read_b64_tr_b16 v[44:45], v6 offset:6144
    ds_read_b64_tr_b16 v[46:47], v6 offset:6656
    s_waitcnt lgkmcnt(6)
    v_mfma_f32_32x32x16_bf16 v[64:79], v[28:31], v[16:19], v[64:79]
    v_add_u32 v4, s62, v4
    s_add_u32 s60, s60, 1
    s_add_u32 s61, s61, 16384
    s_cmp_eq_u32 s61, 49152
    s_cselect_b32 s61, 0, s61
    v_mfma_f32_32x32x16_bf16 v[80:95], v[28:31], v[20:23], v[80:95]
    v_add_u32 v6, s61, v7
    s_cmp_eq_u32 s60, 7
    s_waitcnt lgkmcnt(0)
    s_cbranch_scc1 C_B_TAIL
    s_barrier
    v_mfma_f32_32x32x16_bf16 v[96:111], v[32:35], v[40:43], v[96:111]
    ds_read_b128 v[16:19], v2
    ds_read_b64_tr_b16 v[24:25], v6 offset:8192
    ds_read_b64_tr_b16 v[26:27], v6 offset:8704
    v_mfma_f32_32x32x16_bf16 v[112:127], v[36:39], v[40:43], v[112:127]
    ds_read_b128 v[20:23], v2 offset:4096
    ds_read_b64_tr_b16 v[28:29], v6 offset:0
    ds_read_b64_tr_b16 v[30:31], v6 offset:512
    v_mfma_f32_32x32x16_bf16 v[64:79], v[44:47], v[32:35], v[64:79]
    v_add_u32 v5, s62, v5
    s_add_u32 s63, s60, s91
    s_cmp_eq_u32 s63, 6
    s_cselect_b32 s62, 0xfffe8000, s49
    v_mfma_f32_32x32x16_bf16 v[80:95], v[44:47], v[36:39], v[80:95]
    s_branch C_B_LOOP
C_B_TAIL:
    v_mfma_f32_32x32x16_bf16 v[96:111], v[32:35], v[40:43], v[96:111]
    v_mfma_f32_32x32x16_bf16 v[112:127], v[36:39], v[40:43], v[112:127]
    v_mfma_f32_32x32x16_bf16 v[64:79], v[44:47], v[32:35], v[64:79]
    v_mfma_f32_32x32x16_bf16 v[80:95], v[44:47], v[36:39], v[80:95]
    s_nop 9
    s_mov_b64 exec, s[56:57]
    v_cvt_pk_bf16_f32 v144, v96, v97
    v_cvt_pk_bf16_f32 v145, v98, v99
    v_cvt_pk_bf16_f32 v146, v100, v101
    v_cvt_pk_bf16_f32 v147, v102, v103
    v_cvt_pk_bf16_f32 v148, v104, v105
    v_cvt_pk_bf16_f32 v149, v106, v107
    v_cvt_pk_bf16_f32 v150, v108, v109
    v_cvt_pk_bf16_f32 v151, v110, v111
    v_cvt_pk_bf16_f32 v152, v112, v113
    v_cvt_pk_bf16_f32 v153, v114, v115
    v_cvt_pk_bf16_f32 v154, v116, v117
    v_cvt_pk_bf16_f32 v155, v118, v119
    v_cvt_pk_bf16_f32 v156, v120, v121
    v_cvt_pk_bf16_f32 v157, v122, v123
    v_cvt_pk_bf16_f32 v158, v124, v125
    v_cvt_pk_bf16_f32 v159, v126, v127
    s_mov_b64 exec, -1
    buffer_store_dwordx4 v[144:147], v13, s[52:55], s58 offen offset:2048 sc1
    buffer_store_dwordx4 v[148:151], v13, s[52:55], s58 offen offset:3072 sc1
    buffer_store_dwordx4 v[152:155], v13, s[52:55], s59 offen offset:2048 sc1
    buffer_store_dwordx4 v[156:159], v13, s[52:55], s59 offen offset:3072 sc1
    v_cvt_pk_bf16_f32 v128, v64, v65
    v_cvt_pk_bf16_f32 v129, v66, v67
    v_cvt_pk_bf16_f32 v130, v68, v69
    v_cvt_pk_bf16_f32 v131, v70, v71
    v_cvt_pk_bf16_f32 v132, v72, v73
    v_cvt_pk_bf16_f32 v133, v74, v75
    s_mov_b32 exec_hi, 0
    v_cvt_pk_bf16_f32 v134, v76, v77
    v_cvt_pk_bf16_f32 v135, v78, v79
    s_mov_b32 exec_hi, -1
    buffer_store_dwordx4 v[128:131], v15, s[52:55], s58 offen sc1
    buffer_store_dwordx4 v[132:135], v15, s[52:55], s58 offen offset:1024 sc1
    v_cvt_pk_bf16_f32 v136, v80, v81
    v_cvt_pk_bf16_f32 v137, v82, v83
    v_cvt_pk_bf16_f32 v138, v84, v85
    v_cvt_pk_bf16_f32 v139, v86, v87
    v_cvt_pk_bf16_f32 v140, v88, v89
    v_cvt_pk_bf16_f32 v141, v90, v91
    s_mov_b32 exec_hi, 0
    v_cvt_pk_bf16_f32 v142, v92, v93
    v_cvt_pk_bf16_f32 v143, v94, v95
    s_mov_b32 exec_hi, -1
    buffer_store_dwordx4 v[136:139], v15, s[52:55], s59 offen sc1
    buffer_store_dwordx4 v[140:143], v15, s[52:55], s59 offen offset:1024 sc1
    v_add_u32 v2, 65536, v8
    v_add_u32 v3, 65536, v9
    v_add_u32 v4, 65536, v10
    v_add_u32 v5, 65536, v11
    s_barrier
    ds_read_b128 v[16:19], v8 offset:0
    ds_read_b64_tr_b16 v[20:21], v12 offset:16384
    ds_read_b64_tr_b16 v[22:23], v12 offset:16640
    ds_read_b128 v[24:27], v9 offset:0
    ds_read_b64_tr_b16 v[28:29], v12 offset:17408
    ds_read_b64_tr_b16 v[30:31], v12 offset:17664
    ds_read_b128 v[32:35], v10 offset:0
    ds_read_b64_tr_b16 v[36:37], v12 offset:18432
    ds_read_b64_tr_b16 v[38:39], v12 offset:18688
    s_waitcnt lgkmcnt(6)
    v_mfma_f32_32x32x16_bf16 v[112:127], v[20:23], v[16:19], 0
    ds_read_b128 v[40:43], v11 offset:0
    ds_read_b64_tr_b16 v[44:45], v12 offset:19456
    ds_read_b64_tr_b16 v[46:47], v12 offset:19712
    s_waitcnt lgkmcnt(6)
    v_mfma_f32_32x32x16_bf16 v[112:127], v[28:31], v[24:27], v[112:127]
    ds_read_b128 v[16:19], v8 offset:16384
    ds_read_b64_tr_b16 v[20:21], v12 offset:20480
    ds_read_b64_tr_b16 v[22:23], v12 offset:20736
    s_waitcnt lgkmcnt(6)
    v_mfma_f32_32x32x16_bf16 v[112:127], v[36:39], v[32:35], v[112:127]
    ds_read_b128 v[24:27], v9 offset:16384
    ds_read_b64_tr_b16 v[28:29], v12 offset:21504
    ds_read_b64_tr_b16 v[30:31], v12 offset:21760
    s_waitcnt lgkmcnt(6)
    v_mfma_f32_32x32x16_bf16 v[112:127], v[44:47], v[40:43], v[112:127]
    ds_read_b128 v[32:35], v10 offset:16384
    ds_read_b64_tr_b16 v[36:37], v12 offset:22528
    ds_read_b64_tr_b16 v[38:39], v12 offset:22784
    s_waitcnt lgkmcnt(6)
    v_mfma_f32_32x32x16_bf16 v[112:127], v[20:23], v[16:19], v[112:127]
    ds_read_b128 v[40:43], v11 offset:16384
    ds_read_b64_tr_b16 v[44:45], v12 offset:23552
    ds_read_b64_tr_b16 v[46:47], v12 offset:23808
    s_waitcnt lgkmcnt(6)
    v_mfma_f32_32x32x16_bf16 v[112:127], v[28:31], v[24:27], v[112:127]
    ds_read_b128 v[16:19], v8 offset:32768
    ds_read_b64_tr_b16 v[20:21], v12 offset:24576
    ds_read_b64_tr_b16 v[22:23], v12 offset:24832
    s_waitcnt lgkmcnt(6)
    v_mfma_f32_32x32x16_bf16 v[112:127], v[36:39], v[32:35], v[112:127]
    ds_read_b128 v[24:27], v9 offset:32768
    ds_read_b64_tr_b16 v[28:29], v12 offset:25600
    ds_read_b64_tr_b16 v[30:31], v12 offset:25856
    s_waitcnt lgkmcnt(6)
    v_mfma_f32_32x32x16_bf16 v[112:127], v[44:47], v[40:43], v[112:127]
    ds_read_b128 v[32:35], v10 offset:32768
    ds_read_b64_tr_b16 v[36:37], v12 offset:26624
    ds_read_b64_tr_b16 v[38:39], v12 offset:26880
    s_waitcnt lgkmcnt(6)
    v_mfma_f32_32x32x16_bf16 v[112:127], v[20:23], v[16:19], v[112:127]
    ds_read_b128 v[40:43], v11 offset:32768
    ds_read_b64_tr_b16 v[44:45], v12 offset:27648
    ds_read_b64_tr_b16 v[46:47], v12 offset:27904
    s_waitcnt lgkmcnt(6)
    v_mfma_f32_32x32x16_bf16 v[112:127], v[28:31], v[24:27], v[112:127]
    ds_read_b128 v[16:19], v8 offset:49152
    ds_read_b64_tr_b16 v[20:21], v12 offset:28672
    ds_read_b64_tr_b16 v[22:23], v12 offset:28928
    s_waitcnt lgkmcnt(6)
    v_mfma_f32_32x32x16_bf16 v[112:127], v[36:39], v[32:35], v[112:127]
    ds_read_b128 v[24:27], v9 offset:49152
    ds_read_b64_tr_b16 v[28:29], v12 offset:29696
    ds_read_b64_tr_b16 v[30:31], v12 offset:29952
    s_waitcnt lgkmcnt(6)
    v_mfma_f32_32x32x16_bf16 v[112:127], v[44:47], v[40:43], v[112:127]
    ds_read_b128 v[32:35], v10 offset:49152
    ds_read_b64_tr_b16 v[36:37], v12 offset:30720
    ds_read_b64_tr_b16 v[38:39], v12 offset:30976
    s_waitcnt lgkmcnt(6)
    v_mfma_f32_32x32x16_bf16 v[112:127], v[20:23], v[16:19], v[112:127]
    ds_read_b128 v[40:43], v11 offset:49152
    ds_read_b64_tr_b16 v[44:45], v12 offset:31744
    ds_read_b64_tr_b16 v[46:47], v12 offset:32000
    s_waitcnt lgkmcnt(6)
    v_mfma_f32_32x32x16_bf16 v[112:127], v[28:31], v[24:27], v[112:127]
    ds_read_b128 v[16:19], v2 offset:0
    ds_read_b64_tr_b16 v[20:21], v12 offset:32768
    ds_read_b64_tr_b16 v[22:23], v12 offset:33024
    s_waitcnt lgkmcnt(6)
    v_mfma_f32_32x32x16_bf16 v[112:127], v[36:39], v[32:35], v[112:127]
    ds_read_b128 v[24:27], v3 offset:0
    ds_read_b64_tr_b16 v[28:29], v12 offset:33792
    ds_read_b64_tr_b16 v[30:31], v12 offset:34048
    s_waitcnt lgkmcnt(6)
    v_mfma_f32_32x32x16_bf16 v[112:127], v[44:47], v[40:43], v[112:127]
    ds_read_b128 v[32:35], v4 offset:0
    ds_read_b64_tr_b16 v[36:37], v12 offset:34816
    ds_read_b64_tr_b16 v[38:39], v12 offset:35072
    s_waitcnt lgkmcnt(6)
    v_mfma_f32_32x32x16_bf16 v[112:127], v[20:23], v[16:19], v[112:127]
    ds_read_b128 v[40:43], v5 offset:0
    ds_read_b64_tr_b16 v[44:45], v12 offset:35840
    ds_read_b64_tr_b16 v[46:47], v12 offset:36096
    s_barrier
    s_waitcnt lgkmcnt(6)
    v_mfma_f32_32x32x16_bf16 v[112:127], v[28:31], v[24:27], v[112:127]
    ds_read_b128 v[16:19], v2 offset:16384
    ds_read_b64_tr_b16 v[20:21], v12 offset:36864
    ds_read_b64_tr_b16 v[22:23], v12 offset:37120
    s_waitcnt lgkmcnt(6)
    v_mfma_f32_32x32x16_bf16 v[112:127], v[36:39], v[32:35], v[112:127]
    ds_read_b128 v[24:27], v3 offset:16384
    ds_read_b64_tr_b16 v[28:29], v12 offset:37888
    ds_read_b64_tr_b16 v[30:31], v12 offset:38144
    s_waitcnt lgkmcnt(6)
    v_mfma_f32_32x32x16_bf16 v[112:127], v[44:47], v[40:43], v[112:127]
    ds_read_b128 v[32:35], v4 offset:16384
    ds_read_b64_tr_b16 v[36:37], v12 offset:38912
    ds_read_b64_tr_b16 v[38:39], v12 offset:39168
    s_waitcnt lgkmcnt(6)
    v_mfma_f32_32x32x16_bf16 v[112:127], v[20:23], v[16:19], v[112:127]
    ds_read_b128 v[40:43], v5 offset:16384
    ds_read_b64_tr_b16 v[44:45], v12 offset:39936
    ds_read_b64_tr_b16 v[46:47], v12 offset:40192
    s_waitcnt lgkmcnt(6)
    v_mfma_f32_32x32x16_bf16 v[112:127], v[28:31], v[24:27], v[112:127]
    ds_read_b128 v[16:19], v2 offset:32768
    ds_read_b64_tr_b16 v[20:21], v12 offset:40960
    ds_read_b64_tr_b16 v[22:23], v12 offset:41216
    s_waitcnt lgkmcnt(6)
    v_mfma_f32_32x32x16_bf16 v[112:127], v[36:39], v[32:35], v[112:127]
    ds_read_b128 v[24:27], v3 offset:32768
    ds_read_b64_tr_b16 v[28:29], v12 offset:41984
    ds_read_b64_tr_b16 v[30:31], v12 offset:42240
    s_waitcnt lgkmcnt(6)
    v_mfma_f32_32x32x16_bf16 v[112:127], v[44:47], v[40:43], v[112:127]
    ds_read_b128 v[32:35], v4 offset:32768
    ds_read_b64_tr_b16 v[36:37], v12 offset:43008
    ds_read_b64_tr_b16 v[38:39], v12 offset:43264
    s_waitcnt lgkmcnt(6)
    v_mfma_f32_32x32x16_bf16 v[112:127], v[20:23], v[16:19], v[112:127]
    ds_read_b128 v[40:43], v5 offset:32768
    ds_read_b64_tr_b16 v[44:45], v12 offset:44032
    ds_read_b64_tr_b16 v[46:47], v12 offset:44288
    s_waitcnt lgkmcnt(6)
    v_mfma_f32_32x32x16_bf16 v[112:127], v[28:31], v[24:27], v[112:127]
    s_waitcnt lgkmcnt(3)
    v_mfma_f32_32x32x16_bf16 v[112:127], v[36:39], v[32:35], v[112:127]
    s_waitcnt lgkmcnt(0)
    v_mfma_f32_32x32x16_bf16 v[112:127], v[44:47], v[40:43], v[112:127]
    v_add_u32 v1, s39, v13
    s_waitcnt vmcnt(0)
    s_barrier
    s_nop 7
    v_mov_b32 v54, 0
    v_mov_b32 v55, 0
    v_mov_b32 v14, v124
    v_mov_b32 v15, v124
    v_mul_f32 v112, s65, v112
    v_mul_f32 v113, s65, v113
    v_mul_f32 v114, s65, v114
    v_mul_f32 v115, s65, v115
    v_mul_f32 v116, s65, v116
    v_mul_f32 v117, s65, v117
    v_mul_f32 v118, s65, v118
    v_mul_f32 v119, s65, v119
    v_permlane32_swap_b32 v15, v14
    v_cvt_pk_bf16_f32 v48, v112, v113
    v_cvt_pk_bf16_f32 v49, v114, v115
    v_cvt_pk_bf16_f32 v50, v116, v117
    v_cvt_pk_bf16_f32 v51, v118, v119
    ds_write_b128 v1, v[48:51]
    v_mul_f32 v120, s65, v120
    v_mul_f32 v121, s65, v121
    v_mul_f32 v122, s65, v122
    v_mul_f32 v123, s65, v123
    v_mul_f32 v124, s65, v124
    v_mul_f32 v125, s65, v125
    v_mul_f32 v126, s65, v126
    v_mul_f32 v127, s65, v127
    v_cvt_pk_bf16_f32 v52, v120, v121
    v_cvt_pk_bf16_f32 v53, v122, v123
    s_mov_b32 exec_hi, 0
    v_cvt_pk_bf16_f32 v54, v124, v125
    v_cvt_pk_bf16_f32 v55, v126, v127
    s_mov_b32 exec_hi, -1
    ds_write_b128 v1, v[52:55] offset:1024
    s_waitcnt lgkmcnt(0)
    s_barrier
    ds_read_b128 v[16:19], v8 offset:0
    ds_read_b64_tr_b16 v[20:21], v12 offset:0
    ds_read_b64_tr_b16 v[22:23], v12 offset:256
    ds_read_b128 v[24:27], v9 offset:0
    ds_read_b64_tr_b16 v[28:29], v12 offset:1024
    ds_read_b64_tr_b16 v[30:31], v12 offset:1280
    ds_read_b128 v[32:35], v10 offset:0
    ds_read_b64_tr_b16 v[36:37], v12 offset:2048
    ds_read_b64_tr_b16 v[38:39], v12 offset:2304
    s_waitcnt lgkmcnt(6)
    v_mfma_f32_32x32x16_bf16 v[96:111], v[20:23], v[16:19], 1.0
    ds_read_b128 v[40:43], v11 offset:0
    ds_read_b64_tr_b16 v[44:45], v12 offset:3072
    ds_read_b64_tr_b16 v[46:47], v12 offset:3328
    s_waitcnt lgkmcnt(6)
    v_mfma_f32_32x32x16_bf16 v[96:111], v[28:31], v[24:27], v[96:111]
    ds_read_b128 v[16:19], v8 offset:16384
    ds_read_b64_tr_b16 v[20:21], v12 offset:4096
    ds_read_b64_tr_b16 v[22:23], v12 offset:4352
    s_waitcnt lgkmcnt(6)
    v_mfma_f32_32x32x16_bf16 v[96:111], v[36:39], v[32:35], v[96:111]
    ds_read_b128 v[24:27], v9 offset:16384
    ds_read_b64_tr_b16 v[28:29], v12 offset:5120
    ds_read_b64_tr_b16 v[30:31], v12 offset:5376
    s_waitcnt lgkmcnt(6)
    v_mfma_f32_32x32x16_bf16 v[96:111], v[44:47], v[40:43], v[96:111]
    ds_read_b128 v[32:35], v10 offset:16384
    ds_read_b64_tr_b16 v[36:37], v12 offset:6144
    ds_read_b64_tr_b16 v[38:39], v12 offset:6400
    s_waitcnt lgkmcnt(6)
    v_mfma_f32_32x32x16_bf16 v[96:111], v[20:23], v[16:19], v[96:111]
    ds_read_b128 v[40:43], v11 offset:16384
    ds_read_b64_tr_b16 v[44:45], v12 offset:7168
    ds_read_b64_tr_b16 v[46:47], v12 offset:7424
    s_waitcnt lgkmcnt(6)
    v_mfma_f32_32x32x16_bf16 v[96:111], v[28:31], v[24:27], v[96:111]
    ds_read_b128 v[16:19], v8 offset:32768
    ds_read_b64_tr_b16 v[20:21], v12 offset:8192
    ds_read_b64_tr_b16 v[22:23], v12 offset:8448
    s_waitcnt lgkmcnt(6)
    v_mfma_f32_32x32x16_bf16 v[96:111], v[36:39], v[32:35], v[96:111]
    ds_read_b128 v[24:27], v9 offset:32768
    ds_read_b64_tr_b16 v[28:29], v12 offset:9216
    ds_read_b64_tr_b16 v[30:31], v12 offset:9472
    s_waitcnt lgkmcnt(6)
    v_mfma_f32_32x32x16_bf16 v[96:111], v[44:47], v[40:43], v[96:111]
    ds_read_b128 v[32:35], v10 offset:32768
    ds_read_b64_tr_b16 v[36:37], v12 offset:10240
    ds_read_b64_tr_b16 v[38:39], v12 offset:10496
    s_waitcnt lgkmcnt(6)
    v_mfma_f32_32x32x16_bf16 v[96:111], v[20:23], v[16:19], v[96:111]
    ds_read_b128 v[40:43], v11 offset:32768
    ds_read_b64_tr_b16 v[44:45], v12 offset:11264
    ds_read_b64_tr_b16 v[46:47], v12 offset:11520
    s_waitcnt lgkmcnt(6)
    v_mfma_f32_32x32x16_bf16 v[96:111], v[28:31], v[24:27], v[96:111]
    ds_read_b128 v[16:19], v8 offset:49152
    ds_read_b64_tr_b16 v[20:21], v12 offset:12288
    ds_read_b64_tr_b16 v[22:23], v12 offset:12544
    s_waitcnt lgkmcnt(6)
    v_mfma_f32_32x32x16_bf16 v[96:111], v[36:39], v[32:35], v[96:111]
    ds_read_b128 v[24:27], v9 offset:49152
    ds_read_b64_tr_b16 v[28:29], v12 offset:13312
    ds_read_b64_tr_b16 v[30:31], v12 offset:13568
    s_waitcnt lgkmcnt(6)
    v_mfma_f32_32x32x16_bf16 v[96:111], v[44:47], v[40:43], v[96:111]
    ds_read_b128 v[32:35], v10 offset:49152
    ds_read_b64_tr_b16 v[36:37], v12 offset:14336
    ds_read_b64_tr_b16 v[38:39], v12 offset:14592
    s_waitcnt lgkmcnt(6)
    v_mfma_f32_32x32x16_bf16 v[96:111], v[20:23], v[16:19], v[96:111]
    ds_read_b128 v[40:43], v11 offset:49152
    ds_read_b64_tr_b16 v[44:45], v12 offset:15360
    ds_read_b64_tr_b16 v[46:47], v12 offset:15616
    s_barrier
    s_waitcnt lgkmcnt(6)
    v_mfma_f32_32x32x16_bf16 v[96:111], v[28:31], v[24:27], v[96:111]
    ds_read_b128 v[16:19], v2 offset:0
    ds_read_b64_tr_b16 v[20:21], v12 offset:16384
    ds_read_b64_tr_b16 v[22:23], v12 offset:16640
    s_waitcnt lgkmcnt(6)
    v_mfma_f32_32x32x16_bf16 v[96:111], v[36:39], v[32:35], v[96:111]
    ds_read_b128 v[24:27], v3 offset:0
    ds_read_b64_tr_b16 v[28:29], v12 offset:17408
    ds_read_b64_tr_b16 v[30:31], v12 offset:17664
    s_waitcnt lgkmcnt(6)
    v_mfma_f32_32x32x16_bf16 v[96:111], v[44:47], v[40:43], v[96:111]
    ds_read_b128 v[32:35], v4 offset:0
    ds_read_b64_tr_b16 v[36:37], v12 offset:18432
    ds_read_b64_tr_b16 v[38:39], v12 offset:18688
    s_waitcnt lgkmcnt(6)
    v_mfma_f32_32x32x16_bf16 v[96:111], v[20:23], v[16:19], v[96:111]
    ds_read_b128 v[40:43], v5 offset:0
    ds_read_b64_tr_b16 v[44:45], v12 offset:19456
    ds_read_b64_tr_b16 v[46:47], v12 offset:19712
    s_waitcnt lgkmcnt(6)
    v_mfma_f32_32x32x16_bf16 v[96:111], v[28:31], v[24:27], v[96:111]
    ds_read_b128 v[16:19], v2 offset:16384
    ds_read_b64_tr_b16 v[20:21], v12 offset:20480
    ds_read_b64_tr_b16 v[22:23], v12 offset:20736
    s_waitcnt lgkmcnt(6)
    v_mfma_f32_32x32x16_bf16 v[96:111], v[36:39], v[32:35], v[96:111]
    ds_read_b128 v[24:27], v3 offset:16384
    ds_read_b64_tr_b16 v[28:29], v12 offset:21504
    ds_read_b64_tr_b16 v[30:31], v12 offset:21760
    s_waitcnt lgkmcnt(6)
    v_mfma_f32_32x32x16_bf16 v[96:111], v[44:47], v[40:43], v[96:111]
    ds_read_b128 v[32:35], v4 offset:16384
    ds_read_b64_tr_b16 v[36:37], v12 offset:22528
    ds_read_b64_tr_b16 v[38:39], v12 offset:22784
    s_waitcnt lgkmcnt(6)
    v_mfma_f32_32x32x16_bf16 v[96:111], v[20:23], v[16:19], v[96:111]
    ds_read_b128 v[40:43], v5 offset:16384
    ds_read_b64_tr_b16 v[44:45], v12 offset:23552
    ds_read_b64_tr_b16 v[46:47], v12 offset:23808
    s_waitcnt lgkmcnt(6)
    v_mfma_f32_32x32x16_bf16 v[96:111], v[28:31], v[24:27], v[96:111]
    ds_read_b128 v[16:19], v2 offset:32768
    ds_read_b64_tr_b16 v[20:21], v12 offset:24576
    ds_read_b64_tr_b16 v[22:23], v12 offset:24832
    s_waitcnt lgkmcnt(6)
    v_mfma_f32_32x32x16_bf16 v[96:111], v[36:39], v[32:35], v[96:111]
    ds_read_b128 v[24:27], v3 offset:32768
    ds_read_b64_tr_b16 v[28:29], v12 offset:25600
    ds_read_b64_tr_b16 v[30:31], v12 offset:25856
    s_waitcnt lgkmcnt(6)
    v_mfma_f32_32x32x16_bf16 v[96:111], v[44:47], v[40:43], v[96:111]
    ds_read_b128 v[32:35], v4 offset:32768
    ds_read_b64_tr_b16 v[36:37], v12 offset:26624
    ds_read_b64_tr_b16 v[38:39], v12 offset:26880
    s_waitcnt lgkmcnt(6)
    v_mfma_f32_32x32x16_bf16 v[96:111], v[20:23], v[16:19], v[96:111]
    ds_read_b128 v[40:43], v5 offset:32768
    ds_read_b64_tr_b16 v[44:45], v12 offset:27648
    ds_read_b64_tr_b16 v[46:47], v12 offset:27904
    s_waitcnt lgkmcnt(6)
    v_mfma_f32_32x32x16_bf16 v[96:111], v[28:31], v[24:27], v[96:111]
    s_waitcnt lgkmcnt(3)
    v_mfma_f32_32x32x16_bf16 v[96:111], v[36:39], v[32:35], v[96:111]
    s_waitcnt lgkmcnt(0)
    v_mfma_f32_32x32x16_bf16 v[96:111], v[44:47], v[40:43], v[96:111]
    s_nop 7
    v_accvgpr_write_b32 a92, 0
    v_accvgpr_write_b32 a93, 0
    v_accvgpr_write_b32 a94, 0
    v_accvgpr_write_b32 a95, 0
    v_add_u32 v4, s44, v13
    v_mov_b32 v5, 145408
    v_mov_b32 v6, 1
    v_mul_f32 v14, 0xbfb8aa3b, v14
    v_exp_f32 v14, v14
    v_lshl_add_u32 v15, v0, 2, s48
    v_add_f32 v14, 1.0, v14
    v_rcp_f32 v14, v14
    s_nop 0
    ds_write_b32 v15, v14
    v_sub_f32 v14, 1.0, v14
    v_mfma_f32_32x32x16_bf16 v[16:31], a[92:95], a[92:95], 0
    v_mov_b32 v126, 0
    v_mov_b32 v127, 0
    v_fma_f32 v112, v96, s64, -s64
    v_fma_f32 v113, v97, s64, -s64
    v_fma_f32 v114, v98, s64, -s64
    v_fma_f32 v115, v99, s64, -s64
    v_fma_f32 v116, v100, s64, -s64
    v_mfma_f32_32x32x16_bf16 v[32:47], a[92:95], a[92:95], 0
    v_fma_f32 v117, v101, s64, -s64
    v_fma_f32 v118, v102, s64, -s64
    v_fma_f32 v119, v103, s64, -s64
    v_exp_f32_e64 v112, v112 clamp
    v_exp_f32_e64 v113, v113 clamp
    v_exp_f32_e64 v114, v114 clamp
    v_exp_f32_e64 v115, v115 clamp
    v_mfma_f32_32x32x16_bf16 v[48:63], a[92:95], a[92:95], 0
    v_exp_f32_e64 v116, v116 clamp
    v_exp_f32_e64 v117, v117 clamp
    v_exp_f32_e64 v118, v118 clamp
    v_exp_f32_e64 v119, v119 clamp
    v_max_f32 v96, v96, v112
    v_max_f32 v97, v97, v113
    v_max_f32 v98, v98, v114
    v_mfma_f32_32x32x16_bf16 v[64:79], a[92:95], a[92:95], 0
    v_max_f32 v99, v99, v115
    v_max_f32 v100, v100, v116
    v_max_f32 v101, v101, v117
    v_max_f32 v102, v102, v118
    v_max_f32 v103, v103, v119
    v_add_f32 v96, s66, v96
    v_add_f32 v97, s66, v97
    v_mfma_f32_32x32x16_bf16 v[128:143], a[92:95], a[92:95], 0
    v_add_f32 v98, s66, v98
    v_add_f32 v99, s66, v99
    v_add_f32 v100, s66, v100
    v_add_f32 v101, s66, v101
    v_add_f32 v102, s66, v102
    v_add_f32 v103, s66, v103
    v_fma_f32 v112, v104, s64, -s64
    v_fma_f32 v113, v105, s64, -s64
    v_fma_f32 v114, v106, s64, -s64
    v_fma_f32 v115, v107, s64, -s64
    v_fma_f32 v116, v108, s64, -s64
    v_fma_f32 v117, v109, s64, -s64
    v_fma_f32 v118, v110, s64, -s64
    v_fma_f32 v119, v111, s64, -s64
    v_exp_f32_e64 v112, v112 clamp
    v_exp_f32_e64 v113, v113 clamp
    v_exp_f32_e64 v114, v114 clamp
    v_exp_f32_e64 v115, v115 clamp
    v_exp_f32_e64 v116, v116 clamp
    v_exp_f32_e64 v117, v117 clamp
    v_exp_f32_e64 v118, v118 clamp
    v_exp_f32_e64 v119, v119 clamp
    v_max_f32 v104, v104, v112
    v_max_f32 v105, v105, v113
    v_max_f32 v106, v106, v114
    v_max_f32 v107, v107, v115
    v_max_f32 v108, v108, v116
    v_max_f32 v109, v109, v117
    v_max_f32 v110, v110, v118
    v_max_f32 v111, v111, v119
    v_add_f32 v104, s66, v104
    v_add_f32 v105, s66, v105
    v_add_f32 v106, s66, v106
    v_add_f32 v107, s66, v107
    v_add_f32 v108, s66, v108
    v_add_f32 v109, s66, v109
    v_add_f32 v110, s66, v110
    v_add_f32 v111, s66, v111
    v_cvt_pk_bf16_f32 v120, v96, v97
    v_cvt_pk_bf16_f32 v121, v98, v99
    v_cvt_pk_bf16_f32 v122, v100, v101
    v_cvt_pk_bf16_f32 v123, v102, v103
    v_cvt_pk_bf16_f32 v124, v104, v105
    v_cvt_pk_bf16_f32 v125, v106, v107
    s_mov_b32 exec_hi, 0
    v_cvt_pk_bf16_f32 v126, v108, v109
    v_cvt_pk_bf16_f32 v127, v110, v111
    s_mov_b32 exec_hi, -1
    ds_write_b128 v1, v[120:123] offset:8192
    ds_write_b128 v1, v[124:127] offset:9216
    s_waitcnt lgkmcnt(0)
    s_barrier
    v_add_u32 v7, s45, v13
    s_mov_b32 s58, 4096
    s_mov_b32 s59, 8192
    buffer_load_dwordx4 a[32:35], v7, s[52:55], 0 offen sc1
    v_add_u32 v8, s36, v13
    ds_read_b128 a[0:3], v8
    ds_read_b128 a[4:7], v8 offset:1024
    buffer_load_dwordx4 a[36:39], v7, s[52:55], 0 offen offset:1024 sc1
    v_add_u32 v9, s37, v13
    ds_read_b128 a[8:11], v9
    ds_read_b128 a[12:15], v9 offset:1024
    buffer_load_dwordx4 a[40:43], v7, s[52:55], 0 offen offset:2048 sc1
    v_add_u32 v10, s38, v13
    ds_read_b128 a[16:19], v10
    ds_read_b128 a[20:23], v10 offset:1024
    buffer_load_dwordx4 a[44:47], v7, s[52:55], 0 offen offset:3072 sc1
    v_add_u32 v11, s39, v13
    ds_read_b128 a[24:27], v11
    ds_read_b128 a[28:31], v11 offset:1024
    buffer_load_dwordx4 a[48:51], v7, s[52:55], s58 offen sc1
    buffer_load_dwordx4 a[52:55], v7, s[52:55], s58 offen offset:1024 sc1
    buffer_load_dwordx4 a[56:59], v7, s[52:55], s58 offen offset:2048 sc1
    buffer_load_dwordx4 a[60:63], v7, s[52:55], s58 offen offset:3072 sc1
    buffer_load_dwordx4 a[64:67], v7, s[52:55], s59 offen sc1
    buffer_load_dwordx4 a[68:71], v7, s[52:55], s59 offen offset:1024 sc1
    buffer_load_dwordx4 a[72:75], v7, s[52:55], s59 offen offset:2048 sc1
    buffer_load_dwordx4 a[76:79], v7, s[52:55], s59 offen offset:3072 sc1
    s_mov_b32 s58, 12288
    s_branch C_2
C_A:
    v_mov_b32 v64, 1.0
    v_mov_b32 v65, 1.0
    v_mov_b32 v66, 1.0
    v_mov_b32 v67, 1.0
    v_mov_b32 v68, 1.0
    v_mov_b32 v69, 1.0
    v_mov_b32 v70, 1.0
    v_mov_b32 v71, 1.0
    v_mov_b32 v72, 1.0
    v_mov_b32 v73, 1.0
    v_mov_b32 v74, 1.0
    v_mov_b32 v75, 1.0
    v_mov_b32 v76, 1.0
    v_mov_b32 v77, 1.0
    v_mov_b32 v78, 1.0
    v_mov_b32 v79, 1.0
    v_mov_b32 v80, 1.0
    v_mov_b32 v81, 1.0
    v_mov_b32 v82, 1.0
    v_mov_b32 v83, 1.0
    v_mov_b32 v84, 1.0
    v_mov_b32 v85, 1.0
    v_mov_b32 v86, 1.0
    v_mov_b32 v87, 1.0
    v_mov_b32 v88, 1.0
    v_mov_b32 v89, 1.0
    v_mov_b32 v90, 1.0
    v_mov_b32 v91, 1.0
    v_mov_b32 v92, 1.0
    v_mov_b32 v93, 1.0
    v_mov_b32 v94, 1.0
    v_mov_b32 v95, 1.0
    v_mov_b32 v128, 0
    v_mov_b32 v129, 0
    v_mov_b32 v130, 0
    v_mov_b32 v131, 0
    v_mov_b32 v132, 0
    v_mov_b32 v133, 0
    v_mov_b32 v134, 0
    v_mov_b32 v135, 0
    v_mov_b32 v136, 0
    v_mov_b32 v137, 0
    v_mov_b32 v138, 0
    v_mov_b32 v139, 0
    v_mov_b32 v140, 0
    v_mov_b32 v141, 0
    v_mov_b32 v142, 0
    v_mov_b32 v143, 0
    s_add_u32 s60, s27, 1
    s_and_b32 s60, s60, 3
    s_lshl_b32 s36, s60, 11
    s_add_u32 s36, s36, 147456
    s_mul_i32 s40, s60, 12288
    s_add_u32 s40, s40, 114688
    s_add_u32 s60, s27, 2
    s_and_b32 s60, s60, 3
    s_lshl_b32 s37, s60, 11
    s_add_u32 s37, s37, 147456
    s_mul_i32 s41, s60, 12288
    s_add_u32 s41, s41, 118784
    s_add_u32 s60, s27, 3
    s_and_b32 s60, s60, 3
    s_lshl_b32 s38, s60, 11
    s_add_u32 s38, s38, 147456
    s_mul_i32 s42, s60, 12288
    s_add_u32 s42, s42, 122880
    s_add_u32 s60, s27, 4
    s_and_b32 s60, s60, 3
    s_lshl_b32 s39, s60, 11
    s_add_u32 s39, s39, 147456
    s_mul_i32 s43, s60, 12288
    s_add_u32 s43, s43, 114688
    s_mul_i32 s44, s28, 278528
    s_mul_i32 s45, s27, 69632
    s_add_u32 s45, s45, s44
    s_lshl_b32 s46, s24, 2
    s_add_u32 s46, s46, s27
    s_mul_i32 s46, s46, 69632
    s_lshl_b32 s60, s28, 11
    s_add_u32 s46, s46, s60
    s_add_u32 s46, s46, 8421376
    s_lshl_b32 s47, s27, 12
    s_add_u32 s47, s47, 114688
    s_lshl_b32 s48, s27, 8
    s_add_u32 s48, s48, 146432
    s_mov_b32 s60, 0
    s_mov_b32 s61, 0
    s_mov_b32 s49, 16384
    s_lshl_b32 s62, s91, 14
    v_add_u32 v2, s62, v2
    v_add_u32 v3, s62, v3
    v_add_u32 v4, s62, v4
    v_add_u32 v5, s62, v5
    s_cmp_eq_u32 s91, 6
    s_cselect_b32 s62, 0xfffe8000, s49
    s_barrier
    ds_read_b128 v[16:19], v2
    ds_read_b64_tr_b16 v[24:25], v6 offset:8192
    ds_read_b64_tr_b16 v[26:27], v6 offset:8704
    ds_read_b128 v[20:23], v2 offset:4096
    ds_read_b64_tr_b16 v[28:29], v6 offset:0
    ds_read_b64_tr_b16 v[30:31], v6 offset:512
.p2align 6
C_A_LOOP:
    s_waitcnt lgkmcnt(3)
    v_mfma_f32_32x32x16_bf16 v[96:111], v[16:19], v[24:27], v[96:111]
    ds_read_b128 v[32:35], v3
    ds_read_b64_tr_b16 v[40:41], v6 offset:10240
    ds_read_b64_tr_b16 v[42:43], v6 offset:10752
    s_waitcnt lgkmcnt(5)
    v_mfma_f32_32x32x16_bf16 v[112:127], v[20:23], v[24:27], v[112:127]
    ds_read_b128 v[36:39], v3 offset:4096
    ds_read_b64_tr_b16 v[44:45], v6 offset:2048
    ds_read_b64_tr_b16 v[46:47], v6 offset:2560
    s_waitcnt lgkmcnt(6)
    v_mfma_f32_32x32x16_bf16 v[64:79], v[16:19], v[28:31], v[64:79]
    v_add_u32 v2, s62, v2
    v_mfma_f32_32x32x16_bf16 v[80:95], v[20:23], v[28:31], v[80:95]
    s_waitcnt lgkmcnt(3)
    v_mfma_f32_32x32x16_bf16 v[96:111], v[32:35], v[40:43], v[96:111]
    ds_read_b128 v[16:19], v4
    ds_read_b64_tr_b16 v[24:25], v6 offset:12288
    ds_read_b64_tr_b16 v[26:27], v6 offset:12800
    s_waitcnt lgkmcnt(5)
    v_mfma_f32_32x32x16_bf16 v[112:127], v[36:39], v[40:43], v[112:127]
    ds_read_b128 v[20:23], v4 offset:4096
    ds_read_b64_tr_b16 v[28:29], v6 offset:4096
    ds_read_b64_tr_b16 v[30:31], v6 offset:4608
    s_waitcnt lgkmcnt(6)
    v_mfma_f32_32x32x16_bf16 v[64:79], v[32:35], v[44:47], v[64:79]
    v_add_u32 v3, s62, v3
    v_mfma_f32_32x32x16_bf16 v[80:95], v[36:39], v[44:47], v[80:95]
    s_waitcnt lgkmcnt(3)
    v_mfma_f32_32x32x16_bf16 v[96:111], v[16:19], v[24:27], v[96:111]
    ds_read_b128 v[32:35], v5
    ds_read_b64_tr_b16 v[40:41], v6 offset:14336
    ds_read_b64_tr_b16 v[42:43], v6 offset:14848
    s_waitcnt lgkmcnt(5)
    v_mfma_f32_32x32x16_bf16 v[112:127], v[20:23], v[24:27], v[112:127]
    ds_read_b128 v[36:39], v5 offset:4096
    ds_read_b64_tr_b16 v[44:45], v6 offset:6144
    ds_read_b64_tr_b16 v[46:47], v6 offset:6656
    s_waitcnt lgkmcnt(6)
    v_mfma_f32_32x32x16_bf16 v[64:79], v[16:19], v[28:31], v[64:79]
    v_add_u32 v4, s62, v4
    s_add_u32 s60, s60, 1
    s_add_u32 s61, s61, 16384
    s_cmp_eq_u32 s61, 49152
    s_cselect_b32 s61, 0, s61
    v_mfma_f32_32x32x16_bf16 v[80:95], v[20:23], v[28:31], v[80:95]
    v_add_u32 v6, s61, v7
    s_cmp_eq_u32 s60, 7
    s_waitcnt lgkmcnt(0)
    s_cbranch_scc1 C_A_TAIL
    s_barrier
    v_mfma_f32_32x32x16_bf16 v[96:111], v[32:35], v[40:43], v[96:111]
    ds_read_b128 v[16:19], v2
    ds_read_b64_tr_b16 v[24:25], v6 offset:8192
    ds_read_b64_tr_b16 v[26:27], v6 offset:8704
    v_mfma_f32_32x32x16_bf16 v[112:127], v[36:39], v[40:43], v[112:127]
    ds_read_b128 v[20:23], v2 offset:4096
    ds_read_b64_tr_b16 v[28:29], v6 offset:0
    ds_read_b64_tr_b16 v[30:31], v6 offset:512
    v_mfma_f32_32x32x16_bf16 v[64:79], v[32:35], v[44:47], v[64:79]
    v_add_u32 v5, s62, v5
    s_add_u32 s63, s60, s91
    s_cmp_eq_u32 s63, 6
    s_cselect_b32 s62, 0xfffe8000, s49
    v_mfma_f32_32x32x16_bf16 v[80:95], v[36:39], v[44:47], v[80:95]
    s_branch C_A_LOOP
C_A_TAIL:
    v_mfma_f32_32x32x16_bf16 v[96:111], v[32:35], v[40:43], v[96:111]
    v_mfma_f32_32x32x16_bf16 v[112:127], v[36:39], v[40:43], v[112:127]
    v_mfma_f32_32x32x16_bf16 v[64:79], v[32:35], v[44:47], v[64:79]
    v_mfma_f32_32x32x16_bf16 v[80:95], v[36:39], v[44:47], v[80:95]
    s_nop 9
    s_mov_b64 exec, s[56:57]
    v_cvt_pk_bf16_f32 v144, v96, v97
    v_cvt_pk_bf16_f32 v145, v98, v99
    v_cvt_pk_bf16_f32 v146, v100, v101
    v_cvt_pk_bf16_f32 v147, v102, v103
    v_cvt_pk_bf16_f32 v148, v104, v105
    v_cvt_pk_bf16_f32 v149, v106, v107
    v_cvt_pk_bf16_f32 v150, v108, v109
    v_cvt_pk_bf16_f32 v151, v110, v111
    v_cvt_pk_bf16_f32 v152, v112, v113
    v_cvt_pk_bf16_f32 v153, v114, v115
    v_cvt_pk_bf16_f32 v154, v116, v117
    v_cvt_pk_bf16_f32 v155, v118, v119
    v_cvt_pk_bf16_f32 v156, v120, v121
    v_cvt_pk_bf16_f32 v157, v122, v123
    v_cvt_pk_bf16_f32 v158, v124, v125
    v_cvt_pk_bf16_f32 v159, v126, v127
    s_mov_b64 exec, -1
    v_add_u32 v2, 65536, v8
    v_add_u32 v3, 65536, v9
    v_add_u32 v4, 65536, v10
    v_add_u32 v5, 65536, v11
    s_barrier
    ds_read_b128 v[16:19], v8 offset:0
    ds_read_b64_tr_b16 v[20:21], v12 offset:16384
    ds_read_b64_tr_b16 v[22:23], v12 offset:16640
    ds_read_b128 v[24:27], v9 offset:0
    ds_read_b64_tr_b16 v[28:29], v12 offset:17408
    ds_read_b64_tr_b16 v[30:31], v12 offset:17664
    ds_read_b128 v[32:35], v10 offset:0
    ds_read_b64_tr_b16 v[36:37], v12 offset:18432
    ds_read_b64_tr_b16 v[38:39], v12 offset:18688
    s_waitcnt lgkmcnt(6)
    v_mfma_f32_32x32x16_bf16 v[112:127], v[20:23], v[16:19], 0
    ds_read_b128 v[40:43], v11 offset:0
    ds_read_b64_tr_b16 v[44:45], v12 offset:19456
    ds_read_b64_tr_b16 v[46:47], v12 offset:19712
    s_waitcnt lgkmcnt(6)
    v_mfma_f32_32x32x16_bf16 v[112:127], v[28:31], v[24:27], v[112:127]
    ds_read_b128 v[16:19], v8 offset:16384
    ds_read_b64_tr_b16 v[20:21], v12 offset:20480
    ds_read_b64_tr_b16 v[22:23], v12 offset:20736
    s_waitcnt lgkmcnt(6)
    v_mfma_f32_32x32x16_bf16 v[112:127], v[36:39], v[32:35], v[112:127]
    ds_read_b128 v[24:27], v9 offset:16384
    ds_read_b64_tr_b16 v[28:29], v12 offset:21504
    ds_read_b64_tr_b16 v[30:31], v12 offset:21760
    s_waitcnt lgkmcnt(6)
    v_mfma_f32_32x32x16_bf16 v[112:127], v[44:47], v[40:43], v[112:127]
    ds_read_b128 v[32:35], v10 offset:16384
    ds_read_b64_tr_b16 v[36:37], v12 offset:22528
    ds_read_b64_tr_b16 v[38:39], v12 offset:22784
    s_waitcnt lgkmcnt(6)
    v_mfma_f32_32x32x16_bf16 v[112:127], v[20:23], v[16:19], v[112:127]
    ds_read_b128 v[40:43], v11 offset:16384
    ds_read_b64_tr_b16 v[44:45], v12 offset:23552
    ds_read_b64_tr_b16 v[46:47], v12 offset:23808
    s_waitcnt lgkmcnt(6)
    v_mfma_f32_32x32x16_bf16 v[112:127], v[28:31], v[24:27], v[112:127]
    ds_read_b128 v[16:19], v8 offset:32768
    ds_read_b64_tr_b16 v[20:21], v12 offset:24576
    ds_read_b64_tr_b16 v[22:23], v12 offset:24832
    s_waitcnt lgkmcnt(6)
    v_mfma_f32_32x32x16_bf16 v[112:127], v[36:39], v[32:35], v[112:127]
    ds_read_b128 v[24:27], v9 offset:32768
    ds_read_b64_tr_b16 v[28:29], v12 offset:25600
    ds_read_b64_tr_b16 v[30:31], v12 offset:25856
    s_waitcnt lgkmcnt(6)
    v_mfma_f32_32x32x16_bf16 v[112:127], v[44:47], v[40:43], v[112:127]
    ds_read_b128 v[32:35], v10 offset:32768
    ds_read_b64_tr_b16 v[36:37], v12 offset:26624
    ds_read_b64_tr_b16 v[38:39], v12 offset:26880
    s_waitcnt lgkmcnt(6)
    v_mfma_f32_32x32x16_bf16 v[112:127], v[20:23], v[16:19], v[112:127]
    ds_read_b128 v[40:43], v11 offset:32768
    ds_read_b64_tr_b16 v[44:45], v12 offset:27648
    ds_read_b64_tr_b16 v[46:47], v12 offset:27904
    s_waitcnt lgkmcnt(6)
    v_mfma_f32_32x32x16_bf16 v[112:127], v[28:31], v[24:27], v[112:127]
    ds_read_b128 v[16:19], v8 offset:49152
    ds_read_b64_tr_b16 v[20:21], v12 offset:28672
    ds_read_b64_tr_b16 v[22:23], v12 offset:28928
    s_waitcnt lgkmcnt(6)
    v_mfma_f32_32x32x16_bf16 v[112:127], v[36:39], v[32:35], v[112:127]
    ds_read_b128 v[24:27], v9 offset:49152
    ds_read_b64_tr_b16 v[28:29], v12 offset:29696
    ds_read_b64_tr_b16 v[30:31], v12 offset:29952
    s_waitcnt lgkmcnt(6)
    v_mfma_f32_32x32x16_bf16 v[112:127], v[44:47], v[40:43], v[112:127]
    ds_read_b128 v[32:35], v10 offset:49152
    ds_read_b64_tr_b16 v[36:37], v12 offset:30720
    ds_read_b64_tr_b16 v[38:39], v12 offset:30976
    s_waitcnt lgkmcnt(6)
    v_mfma_f32_32x32x16_bf16 v[112:127], v[20:23], v[16:19], v[112:127]
    ds_read_b128 v[40:43], v11 offset:49152
    ds_read_b64_tr_b16 v[44:45], v12 offset:31744
    ds_read_b64_tr_b16 v[46:47], v12 offset:32000
    s_waitcnt lgkmcnt(6)
    v_mfma_f32_32x32x16_bf16 v[112:127], v[28:31], v[24:27], v[112:127]
    ds_read_b128 v[16:19], v2 offset:0
    ds_read_b64_tr_b16 v[20:21], v12 offset:32768
    ds_read_b64_tr_b16 v[22:23], v12 offset:33024
    s_waitcnt lgkmcnt(6)
    v_mfma_f32_32x32x16_bf16 v[112:127], v[36:39], v[32:35], v[112:127]
    ds_read_b128 v[24:27], v3 offset:0
    ds_read_b64_tr_b16 v[28:29], v12 offset:33792
    ds_read_b64_tr_b16 v[30:31], v12 offset:34048
    s_waitcnt lgkmcnt(6)
    v_mfma_f32_32x32x16_bf16 v[112:127], v[44:47], v[40:43], v[112:127]
    ds_read_b128 v[32:35], v4 offset:0
    ds_read_b64_tr_b16 v[36:37], v12 offset:34816
    ds_read_b64_tr_b16 v[38:39], v12 offset:35072
    s_waitcnt lgkmcnt(6)
    v_mfma_f32_32x32x16_bf16 v[112:127], v[20:23], v[16:19], v[112:127]
    ds_read_b128 v[40:43], v5 offset:0
    ds_read_b64_tr_b16 v[44:45], v12 offset:35840
    ds_read_b64_tr_b16 v[46:47], v12 offset:36096
    s_barrier
    s_waitcnt lgkmcnt(6)
    v_mfma_f32_32x32x16_bf16 v[112:127], v[28:31], v[24:27], v[112:127]
    ds_read_b128 v[16:19], v2 offset:16384
    ds_read_b64_tr_b16 v[20:21], v12 offset:36864
    ds_read_b64_tr_b16 v[22:23], v12 offset:37120
    s_waitcnt lgkmcnt(6)
    v_mfma_f32_32x32x16_bf16 v[112:127], v[36:39], v[32:35], v[112:127]
    ds_read_b128 v[24:27], v3 offset:16384
    ds_read_b64_tr_b16 v[28:29], v12 offset:37888
    ds_read_b64_tr_b16 v[30:31], v12 offset:38144
    s_waitcnt lgkmcnt(6)
    v_mfma_f32_32x32x16_bf16 v[112:127], v[44:47], v[40:43], v[112:127]
    ds_read_b128 v[32:35], v4 offset:16384
    ds_read_b64_tr_b16 v[36:37], v12 offset:38912
    ds_read_b64_tr_b16 v[38:39], v12 offset:39168
    s_waitcnt lgkmcnt(6)
    v_mfma_f32_32x32x16_bf16 v[112:127], v[20:23], v[16:19], v[112:127]
    ds_read_b128 v[40:43], v5 offset:16384
    ds_read_b64_tr_b16 v[44:45], v12 offset:39936
    ds_read_b64_tr_b16 v[46:47], v12 offset:40192
    s_waitcnt lgkmcnt(6)
    v_mfma_f32_32x32x16_bf16 v[112:127], v[28:31], v[24:27], v[112:127]
    ds_read_b128 v[16:19], v2 offset:32768
    ds_read_b64_tr_b16 v[20:21], v12 offset:40960
    ds_read_b64_tr_b16 v[22:23], v12 offset:41216
    s_waitcnt lgkmcnt(6)
    v_mfma_f32_32x32x16_bf16 v[112:127], v[36:39], v[32:35], v[112:127]
    ds_read_b128 v[24:27], v3 offset:32768
    ds_read_b64_tr_b16 v[28:29], v12 offset:41984
    ds_read_b64_tr_b16 v[30:31], v12 offset:42240
    s_waitcnt lgkmcnt(6)
    v_mfma_f32_32x32x16_bf16 v[112:127], v[44:47], v[40:43], v[112:127]
    ds_read_b128 v[32:35], v4 offset:32768
    ds_read_b64_tr_b16 v[36:37], v12 offset:43008
    ds_read_b64_tr_b16 v[38:39], v12 offset:43264
    s_waitcnt lgkmcnt(6)
    v_mfma_f32_32x32x16_bf16 v[112:127], v[20:23], v[16:19], v[112:127]
    ds_read_b128 v[40:43], v5 offset:32768
    ds_read_b64_tr_b16 v[44:45], v12 offset:44032
    ds_read_b64_tr_b16 v[46:47], v12 offset:44288
    s_waitcnt lgkmcnt(6)
    v_mfma_f32_32x32x16_bf16 v[112:127], v[28:31], v[24:27], v[112:127]
    s_waitcnt lgkmcnt(3)
    v_mfma_f32_32x32x16_bf16 v[112:127], v[36:39], v[32:35], v[112:127]
    s_waitcnt lgkmcnt(0)
    v_mfma_f32_32x32x16_bf16 v[112:127], v[44:47], v[40:43], v[112:127]
    v_add_u32 v1, s39, v13
    s_waitcnt vmcnt(0)
    s_barrier
    s_nop 7
    v_mov_b32 v54, 0
    v_mov_b32 v55, 0
    v_mov_b32 v14, v124
    v_mov_b32 v15, v124
    v_mul_f32 v112, s65, v112
    v_mul_f32 v113, s65, v113
    v_mul_f32 v114, s65, v114
    v_mul_f32 v115, s65, v115
    v_mul_f32 v116, s65, v116
    v_mul_f32 v117, s65, v117
    v_mul_f32 v118, s65, v118
    v_mul_f32 v119, s65, v119
    v_permlane32_swap_b32 v15, v14
    v_cvt_pk_bf16_f32 v48, v112, v113
    v_cvt_pk_bf16_f32 v49, v114, v115
    v_cvt_pk_bf16_f32 v50, v116, v117
    v_cvt_pk_bf16_f32 v51, v118, v119
    ds_write_b128 v1, v[48:51]
    v_mul_f32 v120, s65, v120
    v_mul_f32 v121, s65, v121
    v_mul_f32 v122, s65, v122
    v_mul_f32 v123, s65, v123
    v_mul_f32 v124, s65, v124
    v_mul_f32 v125, s65, v125
    v_mul_f32 v126, s65, v126
    v_mul_f32 v127, s65, v127
    v_cvt_pk_bf16_f32 v52, v120, v121
    v_cvt_pk_bf16_f32 v53, v122, v123
    s_mov_b32 exec_hi, 0
    v_cvt_pk_bf16_f32 v54, v124, v125
    v_cvt_pk_bf16_f32 v55, v126, v127
    s_mov_b32 exec_hi, -1
    ds_write_b128 v1, v[52:55] offset:1024
    s_waitcnt lgkmcnt(0)
    s_barrier
    ds_read_b128 v[16:19], v8 offset:0
    ds_read_b64_tr_b16 v[20:21], v12 offset:0
    ds_read_b64_tr_b16 v[22:23], v12 offset:256
    ds_read_b128 v[24:27], v9 offset:0
    ds_read_b64_tr_b16 v[28:29], v12 offset:1024
    ds_read_b64_tr_b16 v[30:31], v12 offset:1280
    ds_read_b128 v[32:35], v10 offset:0
    ds_read_b64_tr_b16 v[36:37], v12 offset:2048
    ds_read_b64_tr_b16 v[38:39], v12 offset:2304
    s_waitcnt lgkmcnt(6)
    v_mfma_f32_32x32x16_bf16 v[96:111], v[20:23], v[16:19], 1.0
    ds_read_b128 v[40:43], v11 offset:0
    ds_read_b64_tr_b16 v[44:45], v12 offset:3072
    ds_read_b64_tr_b16 v[46:47], v12 offset:3328
    s_waitcnt lgkmcnt(6)
    v_mfma_f32_32x32x16_bf16 v[96:111], v[28:31], v[24:27], v[96:111]
    ds_read_b128 v[16:19], v8 offset:16384
    ds_read_b64_tr_b16 v[20:21], v12 offset:4096
    ds_read_b64_tr_b16 v[22:23], v12 offset:4352
    s_waitcnt lgkmcnt(6)
    v_mfma_f32_32x32x16_bf16 v[96:111], v[36:39], v[32:35], v[96:111]
    ds_read_b128 v[24:27], v9 offset:16384
    ds_read_b64_tr_b16 v[28:29], v12 offset:5120
    ds_read_b64_tr_b16 v[30:31], v12 offset:5376
    s_waitcnt lgkmcnt(6)
    v_mfma_f32_32x32x16_bf16 v[96:111], v[44:47], v[40:43], v[96:111]
    ds_read_b128 v[32:35], v10 offset:16384
    ds_read_b64_tr_b16 v[36:37], v12 offset:6144
    ds_read_b64_tr_b16 v[38:39], v12 offset:6400
    s_waitcnt lgkmcnt(6)
    v_mfma_f32_32x32x16_bf16 v[96:111], v[20:23], v[16:19], v[96:111]
    ds_read_b128 v[40:43], v11 offset:16384
    ds_read_b64_tr_b16 v[44:45], v12 offset:7168
    ds_read_b64_tr_b16 v[46:47], v12 offset:7424
    s_waitcnt lgkmcnt(6)
    v_mfma_f32_32x32x16_bf16 v[96:111], v[28:31], v[24:27], v[96:111]
    ds_read_b128 v[16:19], v8 offset:32768
    ds_read_b64_tr_b16 v[20:21], v12 offset:8192
    ds_read_b64_tr_b16 v[22:23], v12 offset:8448
    s_waitcnt lgkmcnt(6)
    v_mfma_f32_32x32x16_bf16 v[96:111], v[36:39], v[32:35], v[96:111]
    ds_read_b128 v[24:27], v9 offset:32768
    ds_read_b64_tr_b16 v[28:29], v12 offset:9216
    ds_read_b64_tr_b16 v[30:31], v12 offset:9472
    s_waitcnt lgkmcnt(6)
    v_mfma_f32_32x32x16_bf16 v[96:111], v[44:47], v[40:43], v[96:111]
    ds_read_b128 v[32:35], v10 offset:32768
    ds_read_b64_tr_b16 v[36:37], v12 offset:10240
    ds_read_b64_tr_b16 v[38:39], v12 offset:10496
    s_waitcnt lgkmcnt(6)
    v_mfma_f32_32x32x16_bf16 v[96:111], v[20:23], v[16:19], v[96:111]
    ds_read_b128 v[40:43], v11 offset:32768
    ds_read_b64_tr_b16 v[44:45], v12 offset:11264
    ds_read_b64_tr_b16 v[46:47], v12 offset:11520
    s_waitcnt lgkmcnt(6)
    v_mfma_f32_32x32x16_bf16 v[96:111], v[28:31], v[24:27], v[96:111]
    ds_read_b128 v[16:19], v8 offset:49152
    ds_read_b64_tr_b16 v[20:21], v12 offset:12288
    ds_read_b64_tr_b16 v[22:23], v12 offset:12544
    s_waitcnt lgkmcnt(6)
    v_mfma_f32_32x32x16_bf16 v[96:111], v[36:39], v[32:35], v[96:111]
    ds_read_b128 v[24:27], v9 offset:49152
    ds_read_b64_tr_b16 v[28:29], v12 offset:13312
    ds_read_b64_tr_b16 v[30:31], v12 offset:13568
    s_waitcnt lgkmcnt(6)
    v_mfma_f32_32x32x16_bf16 v[96:111], v[44:47], v[40:43], v[96:111]
    ds_read_b128 v[32:35], v10 offset:49152
    ds_read_b64_tr_b16 v[36:37], v12 offset:14336
    ds_read_b64_tr_b16 v[38:39], v12 offset:14592
    s_waitcnt lgkmcnt(6)
    v_mfma_f32_32x32x16_bf16 v[96:111], v[20:23], v[16:19], v[96:111]
    ds_read_b128 v[40:43], v11 offset:49152
    ds_read_b64_tr_b16 v[44:45], v12 offset:15360
    ds_read_b64_tr_b16 v[46:47], v12 offset:15616
    s_barrier
    s_waitcnt lgkmcnt(6)
    v_mfma_f32_32x32x16_bf16 v[96:111], v[28:31], v[24:27], v[96:111]
    ds_read_b128 v[16:19], v2 offset:0
    ds_read_b64_tr_b16 v[20:21], v12 offset:16384
    ds_read_b64_tr_b16 v[22:23], v12 offset:16640
    s_waitcnt lgkmcnt(6)
    v_mfma_f32_32x32x16_bf16 v[96:111], v[36:39], v[32:35], v[96:111]
    ds_read_b128 v[24:27], v3 offset:0
    ds_read_b64_tr_b16 v[28:29], v12 offset:17408
    ds_read_b64_tr_b16 v[30:31], v12 offset:17664
    s_waitcnt lgkmcnt(6)
    v_mfma_f32_32x32x16_bf16 v[96:111], v[44:47], v[40:43], v[96:111]
    ds_read_b128 v[32:35], v4 offset:0
    ds_read_b64_tr_b16 v[36:37], v12 offset:18432
    ds_read_b64_tr_b16 v[38:39], v12 offset:18688
    s_waitcnt lgkmcnt(6)
    v_mfma_f32_32x32x16_bf16 v[96:111], v[20:23], v[16:19], v[96:111]
    ds_read_b128 v[40:43], v5 offset:0
    ds_read_b64_tr_b16 v[44:45], v12 offset:19456
    ds_read_b64_tr_b16 v[46:47], v12 offset:19712
    s_waitcnt lgkmcnt(6)
    v_mfma_f32_32x32x16_bf16 v[96:111], v[28:31], v[24:27], v[96:111]
    ds_read_b128 v[16:19], v2 offset:16384
    ds_read_b64_tr_b16 v[20:21], v12 offset:20480
    ds_read_b64_tr_b16 v[22:23], v12 offset:20736
    s_waitcnt lgkmcnt(6)
    v_mfma_f32_32x32x16_bf16 v[96:111], v[36:39], v[32:35], v[96:111]
    ds_read_b128 v[24:27], v3 offset:16384
    ds_read_b64_tr_b16 v[28:29], v12 offset:21504
    ds_read_b64_tr_b16 v[30:31], v12 offset:21760
    s_waitcnt lgkmcnt(6)
    v_mfma_f32_32x32x16_bf16 v[96:111], v[44:47], v[40:43], v[96:111]
    ds_read_b128 v[32:35], v4 offset:16384
    ds_read_b64_tr_b16 v[36:37], v12 offset:22528
    ds_read_b64_tr_b16 v[38:39], v12 offset:22784
    s_waitcnt lgkmcnt(6)
    v_mfma_f32_32x32x16_bf16 v[96:111], v[20:23], v[16:19], v[96:111]
    ds_read_b128 v[40:43], v5 offset:16384
    ds_read_b64_tr_b16 v[44:45], v12 offset:23552
    ds_read_b64_tr_b16 v[46:47], v12 offset:23808
    s_waitcnt lgkmcnt(6)
    v_mfma_f32_32x32x16_bf16 v[96:111], v[28:31], v[24:27], v[96:111]
    ds_read_b128 v[16:19], v2 offset:32768
    ds_read_b64_tr_b16 v[20:21], v12 offset:24576
    ds_read_b64_tr_b16 v[22:23], v12 offset:24832
    s_waitcnt lgkmcnt(6)
    v_mfma_f32_32x32x16_bf16 v[96:111], v[36:39], v[32:35], v[96:111]
    ds_read_b128 v[24:27], v3 offset:32768
    ds_read_b64_tr_b16 v[28:29], v12 offset:25600
    ds_read_b64_tr_b16 v[30:31], v12 offset:25856
    s_waitcnt lgkmcnt(6)
    v_mfma_f32_32x32x16_bf16 v[96:111], v[44:47], v[40:43], v[96:111]
    ds_read_b128 v[32:35], v4 offset:32768
    ds_read_b64_tr_b16 v[36:37], v12 offset:26624
    ds_read_b64_tr_b16 v[38:39], v12 offset:26880
    s_waitcnt lgkmcnt(6)
    v_mfma_f32_32x32x16_bf16 v[96:111], v[20:23], v[16:19], v[96:111]
    ds_read_b128 v[40:43], v5 offset:32768
    ds_read_b64_tr_b16 v[44:45], v12 offset:27648
    ds_read_b64_tr_b16 v[46:47], v12 offset:27904
    s_waitcnt lgkmcnt(6)
    v_mfma_f32_32x32x16_bf16 v[96:111], v[28:31], v[24:27], v[96:111]
    s_waitcnt lgkmcnt(3)
    v_mfma_f32_32x32x16_bf16 v[96:111], v[36:39], v[32:35], v[96:111]
    s_waitcnt lgkmcnt(0)
    v_mfma_f32_32x32x16_bf16 v[96:111], v[44:47], v[40:43], v[96:111]
    v_fma_f32 v52, v64, s64, -s64
    v_fma_f32 v53, v65, s64, -s64
    v_fma_f32 v54, v66, s64, -s64
    v_fma_f32 v55, v67, s64, -s64
    v_fma_f32 v56, v68, s64, -s64
    v_fma_f32 v57, v69, s64, -s64
    v_fma_f32 v58, v70, s64, -s64
    v_fma_f32 v59, v71, s64, -s64
    v_exp_f32_e64 v52, v52 clamp
    v_exp_f32_e64 v53, v53 clamp
    v_exp_f32_e64 v54, v54 clamp
    v_exp_f32_e64 v55, v55 clamp
    v_exp_f32_e64 v56, v56 clamp
    v_exp_f32_e64 v57, v57 clamp
    v_exp_f32_e64 v58, v58 clamp
    v_exp_f32_e64 v59, v59 clamp
    v_max_f32 v64, v64, v52
    v_max_f32 v65, v65, v53
    v_max_f32 v66, v66, v54
    v_max_f32 v67, v67, v55
    v_max_f32 v68, v68, v56
    v_max_f32 v69, v69, v57
    v_max_f32 v70, v70, v58
    v_max_f32 v71, v71, v59
    v_add_f32 v64, s66, v64
    v_add_f32 v65, s66, v65
    v_add_f32 v66, s66, v66
    v_add_f32 v67, s66, v67
    v_add_f32 v68, s66, v68
    v_add_f32 v69, s66, v69
    v_add_f32 v70, s66, v70
    v_add_f32 v71, s66, v71
    v_fma_f32 v52, v72, s64, -s64
    v_fma_f32 v53, v73, s64, -s64
    v_fma_f32 v54, v74, s64, -s64
    v_fma_f32 v55, v75, s64, -s64
    v_fma_f32 v56, v76, s64, -s64
    v_fma_f32 v57, v77, s64, -s64
    v_fma_f32 v58, v78, s64, -s64
    v_fma_f32 v59, v79, s64, -s64
    v_exp_f32_e64 v52, v52 clamp
    v_exp_f32_e64 v53, v53 clamp
    v_exp_f32_e64 v54, v54 clamp
    v_exp_f32_e64 v55, v55 clamp
    v_exp_f32_e64 v56, v56 clamp
    v_exp_f32_e64 v57, v57 clamp
    v_exp_f32_e64 v58, v58 clamp
    v_exp_f32_e64 v59, v59 clamp
    v_max_f32 v72, v72, v52
    v_max_f32 v73, v73, v53
    v_max_f32 v74, v74, v54
    v_max_f32 v75, v75, v55
    v_max_f32 v76, v76, v56
    v_max_f32 v77, v77, v57
    v_max_f32 v78, v78, v58
    v_max_f32 v79, v79, v59
    v_add_f32 v72, s66, v72
    v_add_f32 v73, s66, v73
    v_add_f32 v74, s66, v74
    v_add_f32 v75, s66, v75
    v_add_f32 v76, s66, v76
    v_add_f32 v77, s66, v77
    v_add_f32 v78, s66, v78
    v_add_f32 v79, s66, v79
    v_fma_f32 v52, v80, s64, -s64
    v_fma_f32 v53, v81, s64, -s64
    v_fma_f32 v54, v82, s64, -s64
    v_fma_f32 v55, v83, s64, -s64
    v_fma_f32 v56, v84, s64, -s64
    v_fma_f32 v57, v85, s64, -s64
    v_fma_f32 v58, v86, s64, -s64
    v_fma_f32 v59, v87, s64, -s64
    v_exp_f32_e64 v52, v52 clamp
    v_exp_f32_e64 v53, v53 clamp
    v_exp_f32_e64 v54, v54 clamp
    v_exp_f32_e64 v55, v55 clamp
    v_exp_f32_e64 v56, v56 clamp
    v_exp_f32_e64 v57, v57 clamp
    v_exp_f32_e64 v58, v58 clamp
    v_exp_f32_e64 v59, v59 clamp
    v_max_f32 v80, v80, v52
    v_max_f32 v81, v81, v53
    v_max_f32 v82, v82, v54
    v_max_f32 v83, v83, v55
    v_max_f32 v84, v84, v56
    v_max_f32 v85, v85, v57
    v_max_f32 v86, v86, v58
    v_max_f32 v87, v87, v59
    v_add_f32 v80, s66, v80
    v_add_f32 v81, s66, v81
    v_add_f32 v82, s66, v82
    v_add_f32 v83, s66, v83
    v_add_f32 v84, s66, v84
    v_add_f32 v85, s66, v85
    v_add_f32 v86, s66, v86
    v_add_f32 v87, s66, v87
    v_fma_f32 v52, v88, s64, -s64
    v_fma_f32 v53, v89, s64, -s64
    v_fma_f32 v54, v90, s64, -s64
    v_fma_f32 v55, v91, s64, -s64
    v_fma_f32 v56, v92, s64, -s64
    v_fma_f32 v57, v93, s64, -s64
    v_fma_f32 v58, v94, s64, -s64
    v_fma_f32 v59, v95, s64, -s64
    v_exp_f32_e64 v52, v52 clamp
    v_exp_f32_e64 v53, v53 clamp
    v_exp_f32_e64 v54, v54 clamp
    v_exp_f32_e64 v55, v55 clamp
    v_exp_f32_e64 v56, v56 clamp
    v_exp_f32_e64 v57, v57 clamp
    v_exp_f32_e64 v58, v58 clamp
    v_exp_f32_e64 v59, v59 clamp
    v_max_f32 v88, v88, v52
    v_max_f32 v89, v89, v53
    v_max_f32 v90, v90, v54
    v_max_f32 v91, v91, v55
    v_max_f32 v92, v92, v56
    v_max_f32 v93, v93, v57
    v_max_f32 v94, v94, v58
    v_max_f32 v95, v95, v59
    v_add_f32 v88, s66, v88
    v_add_f32 v89, s66, v89
    v_add_f32 v90, s66, v90
    v_add_f32 v91, s66, v91
    v_add_f32 v92, s66, v92
    v_add_f32 v93, s66, v93
    v_add_f32 v94, s66, v94
    v_add_f32 v95, s66, v95
    s_mov_b64 exec, s[56:57]
    v_cvt_pk_bf16_f32 v128, v64, v65
    v_cvt_pk_bf16_f32 v129, v66, v67
    v_cvt_pk_bf16_f32 v130, v68, v69
    v_cvt_pk_bf16_f32 v131, v70, v71
    v_cvt_pk_bf16_f32 v132, v72, v73
    v_cvt_pk_bf16_f32 v133, v74, v75
    v_cvt_pk_bf16_f32 v134, v76, v77
    v_cvt_pk_bf16_f32 v135, v78, v79
    v_cvt_pk_bf16_f32 v136, v80, v81
    v_cvt_pk_bf16_f32 v137, v82, v83
    v_cvt_pk_bf16_f32 v138, v84, v85
    v_cvt_pk_bf16_f32 v139, v86, v87
    v_cvt_pk_bf16_f32 v140, v88, v89
    v_cvt_pk_bf16_f32 v141, v90, v91
    v_cvt_pk_bf16_f32 v142, v92, v93
    v_cvt_pk_bf16_f32 v143, v94, v95
    s_mov_b64 exec, -1
    s_nop 1
    v_accvgpr_write_b32 a92, 0
    v_accvgpr_write_b32 a93, 0
    v_accvgpr_write_b32 a94, 0
    v_accvgpr_write_b32 a95, 0
    v_add_u32 v4, s44, v13
    v_mov_b32 v5, 145408
    v_mov_b32 v6, 1
    v_mul_f32 v14, 0xbfb8aa3b, v14
    v_exp_f32 v14, v14
    v_lshl_add_u32 v15, v0, 2, s48
    v_add_f32 v14, 1.0, v14
    v_rcp_f32 v14, v14
    s_nop 0
    ds_write_b32 v15, v14
    v_sub_f32 v14, 1.0, v14
    v_mfma_f32_32x32x16_bf16 v[80:95], v[128:131], v[144:147], 0
    v_mov_b32 v126, 0
    v_mov_b32 v127, 0
    v_fma_f32 v112, v96, s64, -s64
    v_fma_f32 v113, v97, s64, -s64
    v_fma_f32 v114, v98, s64, -s64
    v_fma_f32 v115, v99, s64, -s64
    v_fma_f32 v116, v100, s64, -s64
    v_mfma_f32_32x32x16_bf16 v[80:95], v[132:135], v[148:151], v[80:95]
    v_fma_f32 v117, v101, s64, -s64
    v_fma_f32 v118, v102, s64, -s64
    v_fma_f32 v119, v103, s64, -s64
    v_exp_f32_e64 v112, v112 clamp
    v_exp_f32_e64 v113, v113 clamp
    v_exp_f32_e64 v114, v114 clamp
    v_exp_f32_e64 v115, v115 clamp
    v_mfma_f32_32x32x16_bf16 v[80:95], v[136:139], v[152:155], v[80:95]
    v_exp_f32_e64 v116, v116 clamp
    v_exp_f32_e64 v117, v117 clamp
    v_exp_f32_e64 v118, v118 clamp
    v_exp_f32_e64 v119, v119 clamp
    v_max_f32 v96, v96, v112
    v_max_f32 v97, v97, v113
    v_max_f32 v98, v98, v114
    v_mfma_f32_32x32x16_bf16 v[80:95], v[140:143], v[156:159], v[80:95]
    v_max_f32 v99, v99, v115
    v_max_f32 v100, v100, v116
    v_max_f32 v101, v101, v117
    v_max_f32 v102, v102, v118
    v_max_f32 v103, v103, v119
    v_add_f32 v96, s66, v96
    v_add_f32 v97, s66, v97
    v_mfma_f32_32x32x16_bf16 v[16:31], a[92:95], a[92:95], 0
    v_add_f32 v98, s66, v98
    v_add_f32 v99, s66, v99
    v_add_f32 v100, s66, v100
    v_add_f32 v101, s66, v101
    v_add_f32 v102, s66, v102
    v_add_f32 v103, s66, v103
    v_fma_f32 v112, v104, s64, -s64
    v_mfma_f32_32x32x16_bf16 v[32:47], a[92:95], a[92:95], 0
    v_fma_f32 v113, v105, s64, -s64
    v_fma_f32 v114, v106, s64, -s64
    v_fma_f32 v115, v107, s64, -s64
    v_fma_f32 v116, v108, s64, -s64
    v_fma_f32 v117, v109, s64, -s64
    v_fma_f32 v118, v110, s64, -s64
    v_fma_f32 v119, v111, s64, -s64
    v_mfma_f32_32x32x16_bf16 v[48:63], a[92:95], a[92:95], 0
    v_exp_f32_e64 v112, v112 clamp
    v_exp_f32_e64 v113, v113 clamp
    v_exp_f32_e64 v114, v114 clamp
    v_exp_f32_e64 v115, v115 clamp
    v_exp_f32_e64 v116, v116 clamp
    v_exp_f32_e64 v117, v117 clamp
    v_exp_f32_e64 v118, v118 clamp
    v_mfma_f32_32x32x16_bf16 v[64:79], a[92:95], a[92:95], 0
    v_exp_f32_e64 v119, v119 clamp
    v_max_f32 v104, v104, v112
    v_max_f32 v105, v105, v113
    v_max_f32 v106, v106, v114
    v_max_f32 v107, v107, v115
    v_max_f32 v108, v108, v116
    v_max_f32 v109, v109, v117
    v_mfma_f32_32x32x16_bf16 v[128:143], a[92:95], a[92:95], 0
    v_max_f32 v110, v110, v118
    v_max_f32 v111, v111, v119
    v_add_f32 v104, s66, v104
    v_add_f32 v105, s66, v105
    v_add_f32 v106, s66, v106
    v_add_f32 v107, s66, v107
    v_add_f32 v108, s66, v108
    v_add_f32 v109, s66, v109
    v_add_f32 v110, s66, v110
    v_add_f32 v111, s66, v111
    v_cvt_pk_bf16_f32 v120, v96, v97
    v_cvt_pk_bf16_f32 v121, v98, v99
    v_cvt_pk_bf16_f32 v122, v100, v101
    v_cvt_pk_bf16_f32 v123, v102, v103
    v_cvt_pk_bf16_f32 v124, v104, v105
    v_cvt_pk_bf16_f32 v125, v106, v107
    s_mov_b32 exec_hi, 0
    v_cvt_pk_bf16_f32 v126, v108, v109
    v_cvt_pk_bf16_f32 v127, v110, v111
    s_mov_b32 exec_hi, -1
    ds_write_b128 v1, v[120:123] offset:8192
    ds_write_b128 v1, v[124:127] offset:9216
    v_add_u32 v15, s47, v13
    ds_write_b128 v15, v[80:83] offset:0
    ds_write_b128 v15, v[84:87] offset:1024
    ds_write_b128 v15, v[88:91] offset:2048
    ds_write_b128 v15, v[92:95] offset:3072
    s_waitcnt lgkmcnt(0)
    s_barrier
    v_add_u32 v7, s45, v13
    s_mov_b32 s58, 4096
    s_mov_b32 s59, 8192
    buffer_load_dwordx4 a[32:35], v7, s[52:55], 0 offen sc1
    v_add_u32 v8, s36, v13
    ds_read_b128 a[0:3], v8
    ds_read_b128 a[4:7], v8 offset:1024
    buffer_load_dwordx4 a[36:39], v7, s[52:55], 0 offen offset:1024 sc1
    v_add_u32 v9, s37, v13
    ds_read_b128 a[8:11], v9
    ds_read_b128 a[12:15], v9 offset:1024
    buffer_load_dwordx4 a[40:43], v7, s[52:55], 0 offen offset:2048 sc1
    v_add_u32 v10, s38, v13
    ds_read_b128 a[16:19], v10
    ds_read_b128 a[20:23], v10 offset:1024
    buffer_load_dwordx4 a[44:47], v7, s[52:55], 0 offen offset:3072 sc1
    v_add_u32 v11, s39, v13
    ds_read_b128 a[24:27], v11
    ds_read_b128 a[28:31], v11 offset:1024
    buffer_load_dwordx4 a[48:51], v7, s[52:55], s58 offen sc1
    buffer_load_dwordx4 a[52:55], v7, s[52:55], s58 offen offset:1024 sc1
    buffer_load_dwordx4 a[56:59], v7, s[52:55], s58 offen offset:2048 sc1
    buffer_load_dwordx4 a[60:63], v7, s[52:55], s58 offen offset:3072 sc1
    buffer_load_dwordx4 a[64:67], v7, s[52:55], s59 offen sc1
    buffer_load_dwordx4 a[68:71], v7, s[52:55], s59 offen offset:1024 sc1
    buffer_load_dwordx4 a[72:75], v7, s[52:55], s59 offen offset:2048 sc1
    buffer_load_dwordx4 a[76:79], v7, s[52:55], s59 offen offset:3072 sc1
    s_mov_b32 s58, 12288
C_2:
    v_mov_b32 v2, 0xdddd
    v_mov_b32 v3, 0
    v_mov_b32 v1, v7
    s_mov_b32 s49, 3
    v_add_u32 v144, s40, v13
    v_add_u32 v145, s41, v13
    v_add_u32 v146, s42, v13
    v_add_u32 v147, s43, v13
    s_waitcnt vmcnt(10) lgkmcnt(0)
    s_mov_b64 exec, 1
    ds_add_u32 v5, v6 offset:8
    ds_read_b32 v12, v5 offset:20
    s_mov_b64 exec, -1
    v_mfma_f32_32x32x16_bf16 v[80:95], a[32:35], a[0:3], 0
    v_mfma_f32_32x32x16_bf16 v[80:95], a[36:39], a[4:7], v[80:95]
    s_waitcnt vmcnt(8) lgkmcnt(0)
    v_readfirstlane_b32 s87, v12
    s_nop 8
.p2align 6
C_ATT:
    v_mfma_f32_32x32x16_bf16 v[96:111], a[32:35], a[8:11], 0
    v_exp_f32 v80, v80
    v_exp_f32 v81, v81
    v_exp_f32 v82, v82
    v_exp_f32 v83, v83
    v_smfmac_f32_32x32x32_bf16 v[64:79], a[92:95], v[136:143], v2
    s_waitcnt vmcnt(8)
    v_exp_f32 v84, v84
    v_exp_f32 v85, v85
    v_exp_f32 v86, v86
    v_exp_f32 v87, v87
    v_mfma_f32_32x32x16_bf16 v[96:111], a[36:39], a[12:15], v[96:111]
    buffer_load_dwordx4 a[80:83], v1, s[52:55], s58 offen sc1
    v_exp_f32 v88, v88
    v_exp_f32 v89, v89
    v_exp_f32 v90, v90
    v_exp_f32 v91, v91
    v_smfmac_f32_32x32x32_bf16 v[16:31], a[40:43], v[80:87], v2
    s_nop 0
    v_exp_f32 v92, v92
    v_exp_f32 v93, v93
    v_exp_f32 v94, v94
    v_exp_f32 v95, v95
    v_mfma_f32_32x32x16_bf16 v[112:127], a[32:35], a[16:19], 0
    v_exp_f32 v96, v96
    v_exp_f32 v97, v97
    v_exp_f32 v98, v98
    v_exp_f32 v99, v99
    v_smfmac_f32_32x32x32_bf16 v[16:31], a[44:47], v[88:95], v2
    v_exp_f32 v100, v100
    v_exp_f32 v101, v101
    v_exp_f32 v102, v102
    v_exp_f32 v103, v103
    v_mfma_f32_32x32x16_bf16 v[112:127], a[36:39], a[20:23], v[112:127]
    buffer_load_dwordx4 a[84:87], v1, s[52:55], s58 offen offset:1024 sc1
    v_exp_f32 v104, v104
    v_exp_f32 v105, v105
    v_exp_f32 v106, v106
    v_exp_f32 v107, v107
    v_smfmac_f32_32x32x32_bf16 v[32:47], a[40:43], v[96:103], v2
    s_nop 0
    v_exp_f32 v108, v108
    v_exp_f32 v109, v109
    v_exp_f32 v110, v110
    v_exp_f32 v111, v111
    v_mfma_f32_32x32x16_bf16 v[128:143], a[32:35], a[24:27], 0
    v_exp_f32 v112, v112
    v_exp_f32 v113, v113
    v_exp_f32 v114, v114
    v_exp_f32 v115, v115
    v_smfmac_f32_32x32x32_bf16 v[32:47], a[44:47], v[104:111], v2
    v_exp_f32 v116, v116
    v_exp_f32 v117, v117
    v_exp_f32 v118, v118
    v_exp_f32 v119, v119
    v_mfma_f32_32x32x16_bf16 v[128:143], a[36:39], a[28:31], v[128:143]
    buffer_load_dwordx4 a[88:91], v1, s[52:55], s58 offen offset:2048 sc1
    v_exp_f32 v120, v120
    v_exp_f32 v121, v121
    v_exp_f32 v122, v122
    v_exp_f32 v123, v123
    v_smfmac_f32_32x32x32_bf16 v[48:63], a[40:43], v[112:119], v2
    s_waitcnt vmcnt(9)
    v_exp_f32 v124, v124
    v_exp_f32 v125, v125
    v_exp_f32 v126, v126
    v_exp_f32 v127, v127
    v_mfma_f32_32x32x16_bf16 v[80:95], a[48:51], a[0:3], 0
    v_exp_f32 v128, v128
    v_exp_f32 v129, v129
    v_exp_f32 v130, v130
    v_exp_f32 v131, v131
    v_smfmac_f32_32x32x32_bf16 v[48:63], a[44:47], v[120:127], v2
    v_exp_f32 v132, v132
    v_exp_f32 v133, v133
    v_exp_f32 v134, v134
    v_exp_f32 v135, v135
    v_mfma_f32_32x32x16_bf16 v[80:95], a[52:55], a[4:7], v[80:95]
    buffer_load_dwordx4 a[92:95], v1, s[52:55], s58 offen offset:3072 sc1
    v_exp_f32 v136, v136
    v_exp_f32 v137, v137
    v_exp_f32 v138, v138
    v_exp_f32 v139, v139
    v_smfmac_f32_32x32x32_bf16 v[64:79], a[40:43], v[128:135], v2
    s_add_u32 s58, s58, 4096
    v_exp_f32 v140, v140
    v_exp_f32 v141, v141
    v_exp_f32 v142, v142
    v_exp_f32 v143, v143
    v_mfma_f32_32x32x16_bf16 v[96:111], a[48:51], a[8:11], 0
    v_exp_f32 v80, v80
    v_exp_f32 v81, v81
    v_exp_f32 v82, v82
    v_exp_f32 v83, v83
    v_smfmac_f32_32x32x32_bf16 v[64:79], a[44:47], v[136:143], v2
    s_waitcnt vmcnt(8)
    v_exp_f32 v84, v84
    v_exp_f32 v85, v85
    v_exp_f32 v86, v86
    v_exp_f32 v87, v87
    v_mfma_f32_32x32x16_bf16 v[96:111], a[52:55], a[12:15], v[96:111]
    buffer_load_dwordx4 a[32:35], v1, s[52:55], s58 offen sc1
    v_exp_f32 v88, v88
    v_exp_f32 v89, v89
    v_exp_f32 v90, v90
    v_exp_f32 v91, v91
    v_smfmac_f32_32x32x32_bf16 v[16:31], a[56:59], v[80:87], v2
    s_nop 0
    v_exp_f32 v92, v92
    v_exp_f32 v93, v93
    v_exp_f32 v94, v94
    v_exp_f32 v95, v95
    v_mfma_f32_32x32x16_bf16 v[112:127], a[48:51], a[16:19], 0
    v_exp_f32 v96, v96
    v_exp_f32 v97, v97
    v_exp_f32 v98, v98
    v_exp_f32 v99, v99
    v_smfmac_f32_32x32x32_bf16 v[16:31], a[60:63], v[88:95], v2
    v_exp_f32 v100, v100
    v_exp_f32 v101, v101
    v_exp_f32 v102, v102
    v_exp_f32 v103, v103
    v_mfma_f32_32x32x16_bf16 v[112:127], a[52:55], a[20:23], v[112:127]
    buffer_load_dwordx4 a[36:39], v1, s[52:55], s58 offen offset:1024 sc1
    v_exp_f32 v104, v104
    v_exp_f32 v105, v105
    v_exp_f32 v106, v106
    v_exp_f32 v107, v107
    v_smfmac_f32_32x32x32_bf16 v[32:47], a[56:59], v[96:103], v2
    s_nop 0
    v_exp_f32 v108, v108
    v_exp_f32 v109, v109
    v_exp_f32 v110, v110
    v_exp_f32 v111, v111
    v_mfma_f32_32x32x16_bf16 v[128:143], a[48:51], a[24:27], 0
    v_exp_f32 v112, v112
    v_exp_f32 v113, v113
    v_exp_f32 v114, v114
    v_exp_f32 v115, v115
    v_smfmac_f32_32x32x32_bf16 v[32:47], a[60:63], v[104:111], v2
    v_exp_f32 v116, v116
    v_exp_f32 v117, v117
    v_exp_f32 v118, v118
    v_exp_f32 v119, v119
    v_mfma_f32_32x32x16_bf16 v[128:143], a[52:55], a[28:31], v[128:143]
    buffer_load_dwordx4 a[40:43], v1, s[52:55], s58 offen offset:2048 sc1
    v_exp_f32 v120, v120
    v_exp_f32 v121, v121
    v_exp_f32 v122, v122
    v_exp_f32 v123, v123
    v_smfmac_f32_32x32x32_bf16 v[48:63], a[56:59], v[112:119], v2
    s_waitcnt vmcnt(9)
    v_exp_f32 v124, v124
    v_exp_f32 v125, v125
    v_exp_f32 v126, v126
    v_exp_f32 v127, v127
    v_mfma_f32_32x32x16_bf16 v[80:95], a[64:67], a[0:3], 0
    v_exp_f32 v128, v128
    v_exp_f32 v129, v129
    v_exp_f32 v130, v130
    v_exp_f32 v131, v131
    v_smfmac_f32_32x32x32_bf16 v[48:63], a[60:63], v[120:127], v2
    v_exp_f32 v132, v132
    v_exp_f32 v133, v133
    v_exp_f32 v134, v134
    v_exp_f32 v135, v135
    v_mfma_f32_32x32x16_bf16 v[80:95], a[68:71], a[4:7], v[80:95]
    buffer_load_dwordx4 a[44:47], v1, s[52:55], s58 offen offset:3072 sc1
    v_exp_f32 v136, v136
    v_exp_f32 v137, v137
    v_exp_f32 v138, v138
    v_exp_f32 v139, v139
    v_smfmac_f32_32x32x32_bf16 v[64:79], a[56:59], v[128:135], v2
    s_add_u32 s58, s58, 4096
    v_exp_f32 v140, v140
    v_exp_f32 v141, v141
    v_exp_f32 v142, v142
    v_exp_f32 v143, v143
    v_mfma_f32_32x32x16_bf16 v[96:111], a[64:67], a[8:11], 0
    v_exp_f32 v80, v80
    v_exp_f32 v81, v81
    v_exp_f32 v82, v82
    v_exp_f32 v83, v83
    v_smfmac_f32_32x32x32_bf16 v[64:79], a[60:63], v[136:143], v2
    s_waitcnt vmcnt(8)
    v_exp_f32 v84, v84
    v_exp_f32 v85, v85
    v_exp_f32 v86, v86
    v_exp_f32 v87, v87
    v_mfma_f32_32x32x16_bf16 v[96:111], a[68:71], a[12:15], v[96:111]
    buffer_load_dwordx4 a[48:51], v1, s[52:55], s58 offen sc1
    v_exp_f32 v88, v88
    v_exp_f32 v89, v89
    v_exp_f32 v90, v90
    v_exp_f32 v91, v91
    v_smfmac_f32_32x32x32_bf16 v[16:31], a[72:75], v[80:87], v2
    s_nop 0
    v_exp_f32 v92, v92
    v_exp_f32 v93, v93
    v_exp_f32 v94, v94
    v_exp_f32 v95, v95
    v_mfma_f32_32x32x16_bf16 v[112:127], a[64:67], a[16:19], 0
    v_exp_f32 v96, v96
    v_exp_f32 v97, v97
    v_exp_f32 v98, v98
    v_exp_f32 v99, v99
    v_smfmac_f32_32x32x32_bf16 v[16:31], a[76:79], v[88:95], v2
    v_exp_f32 v100, v100
    v_exp_f32 v101, v101
    v_exp_f32 v102, v102
    v_exp_f32 v103, v103
    v_mfma_f32_32x32x16_bf16 v[112:127], a[68:71], a[20:23], v[112:127]
    buffer_load_dwordx4 a[52:55], v1, s[52:55], s58 offen offset:1024 sc1
    v_exp_f32 v104, v104
    v_exp_f32 v105, v105
    v_exp_f32 v106, v106
    v_exp_f32 v107, v107
    v_smfmac_f32_32x32x32_bf16 v[32:47], a[72:75], v[96:103], v2
    s_nop 0
    v_exp_f32 v108, v108
    v_exp_f32 v109, v109
    v_exp_f32 v110, v110
    v_exp_f32 v111, v111
    v_mfma_f32_32x32x16_bf16 v[128:143], a[64:67], a[24:27], 0
    v_exp_f32 v112, v112
    v_exp_f32 v113, v113
    v_exp_f32 v114, v114
    v_exp_f32 v115, v115
    v_smfmac_f32_32x32x32_bf16 v[32:47], a[76:79], v[104:111], v2
    v_exp_f32 v116, v116
    v_exp_f32 v117, v117
    v_exp_f32 v118, v118
    v_exp_f32 v119, v119
    v_mfma_f32_32x32x16_bf16 v[128:143], a[68:71], a[28:31], v[128:143]
    buffer_load_dwordx4 a[56:59], v1, s[52:55], s58 offen offset:2048 sc1
    v_exp_f32 v120, v120
    v_exp_f32 v121, v121
    v_exp_f32 v122, v122
    v_exp_f32 v123, v123
    v_smfmac_f32_32x32x32_bf16 v[48:63], a[72:75], v[112:119], v2
    s_waitcnt vmcnt(9)
    v_exp_f32 v124, v124
    v_exp_f32 v125, v125
    v_exp_f32 v126, v126
    v_exp_f32 v127, v127
    v_mfma_f32_32x32x16_bf16 v[80:95], a[80:83], a[0:3], 0
    v_exp_f32 v128, v128
    v_exp_f32 v129, v129
    v_exp_f32 v130, v130
    v_exp_f32 v131, v131
    v_smfmac_f32_32x32x32_bf16 v[48:63], a[76:79], v[120:127], v2
    v_exp_f32 v132, v132
    v_exp_f32 v133, v133
    v_exp_f32 v134, v134
    v_exp_f32 v135, v135
    v_mfma_f32_32x32x16_bf16 v[80:95], a[84:87], a[4:7], v[80:95]
    buffer_load_dwordx4 a[60:63], v1, s[52:55], s58 offen offset:3072 sc1
    v_exp_f32 v136, v136
    v_exp_f32 v137, v137
    v_exp_f32 v138, v138
    v_exp_f32 v139, v139
    v_smfmac_f32_32x32x32_bf16 v[64:79], a[72:75], v[128:135], v2
    s_add_u32 s58, s58, 4096
    v_exp_f32 v140, v140
    v_exp_f32 v141, v141
    v_exp_f32 v142, v142
    v_exp_f32 v143, v143
    v_mfma_f32_32x32x16_bf16 v[96:111], a[80:83], a[8:11], 0
    v_exp_f32 v80, v80
    v_exp_f32 v81, v81
    v_exp_f32 v82, v82
    v_exp_f32 v83, v83
    v_smfmac_f32_32x32x32_bf16 v[64:79], a[76:79], v[136:143], v2
    s_waitcnt vmcnt(8)
    v_exp_f32 v84, v84
    v_exp_f32 v85, v85
    v_exp_f32 v86, v86
    v_exp_f32 v87, v87
    v_mfma_f32_32x32x16_bf16 v[96:111], a[84:87], a[12:15], v[96:111]
    buffer_load_dwordx4 a[64:67], v1, s[52:55], s58 offen sc1
    v_exp_f32 v88, v88
    v_exp_f32 v89, v89
    v_exp_f32 v90, v90
    v_exp_f32 v91, v91
    v_smfmac_f32_32x32x32_bf16 v[16:31], a[88:91], v[80:87], v2
    s_nop 0
    v_exp_f32 v92, v92
    v_exp_f32 v93, v93
    v_exp_f32 v94, v94
    v_exp_f32 v95, v95
    v_mfma_f32_32x32x16_bf16 v[112:127], a[80:83], a[16:19], 0
    v_exp_f32 v96, v96
    v_exp_f32 v97, v97
    v_exp_f32 v98, v98
    v_exp_f32 v99, v99
    v_smfmac_f32_32x32x32_bf16 v[16:31], a[92:95], v[88:95], v2
    v_exp_f32 v100, v100
    v_exp_f32 v101, v101
    v_exp_f32 v102, v102
    v_exp_f32 v103, v103
    v_mfma_f32_32x32x16_bf16 v[112:127], a[84:87], a[20:23], v[112:127]
    buffer_load_dwordx4 a[68:71], v1, s[52:55], s58 offen offset:1024 sc1
    v_exp_f32 v104, v104
    v_exp_f32 v105, v105
    v_exp_f32 v106, v106
    v_exp_f32 v107, v107
    v_smfmac_f32_32x32x32_bf16 v[32:47], a[88:91], v[96:103], v2
    s_sub_u32 s49, s49, 1
    v_exp_f32 v108, v108
    v_exp_f32 v109, v109
    v_exp_f32 v110, v110
    v_exp_f32 v111, v111
    v_mfma_f32_32x32x16_bf16 v[128:143], a[80:83], a[24:27], 0
    v_exp_f32 v112, v112
    v_exp_f32 v113, v113
    v_exp_f32 v114, v114
    v_exp_f32 v115, v115
    v_smfmac_f32_32x32x32_bf16 v[32:47], a[92:95], v[104:111], v2
    v_exp_f32 v116, v116
    v_exp_f32 v117, v117
    v_exp_f32 v118, v118
    v_exp_f32 v119, v119
    v_mfma_f32_32x32x16_bf16 v[128:143], a[84:87], a[28:31], v[128:143]
    buffer_load_dwordx4 a[72:75], v1, s[52:55], s58 offen offset:2048 sc1
    v_exp_f32 v120, v120
    v_exp_f32 v121, v121
    v_exp_f32 v122, v122
    v_exp_f32 v123, v123
    v_smfmac_f32_32x32x32_bf16 v[48:63], a[88:91], v[112:119], v2
    s_waitcnt vmcnt(9)
    v_exp_f32 v124, v124
    v_exp_f32 v125, v125
    v_exp_f32 v126, v126
    v_exp_f32 v127, v127
    v_mfma_f32_32x32x16_bf16 v[80:95], a[32:35], a[0:3], 0
    v_exp_f32 v128, v128
    v_exp_f32 v129, v129
    v_exp_f32 v130, v130
    v_exp_f32 v131, v131
    v_smfmac_f32_32x32x32_bf16 v[48:63], a[92:95], v[120:127], v2
    v_exp_f32 v132, v132
    v_exp_f32 v133, v133
    v_exp_f32 v134, v134
    v_exp_f32 v135, v135
    v_mfma_f32_32x32x16_bf16 v[80:95], a[36:39], a[4:7], v[80:95]
    buffer_load_dwordx4 a[76:79], v1, s[52:55], s58 offen offset:3072 sc1
    v_exp_f32 v136, v136
    v_exp_f32 v137, v137
    v_exp_f32 v138, v138
    v_exp_f32 v139, v139
    v_smfmac_f32_32x32x32_bf16 v[64:79], a[88:91], v[128:135], v2
    s_add_u32 s58, s58, 4096
    s_cmp_lg_u32 s49, 0
    v_exp_f32 v140, v140
    v_exp_f32 v141, v141
    v_exp_f32 v142, v142
    v_exp_f32 v143, v143
    s_cbranch_scc1 C_ATT
    v_mfma_f32_32x32x16_bf16 v[96:111], a[32:35], a[8:11], 0
    v_exp_f32 v80, v80
    v_exp_f32 v81, v81
    v_exp_f32 v82, v82
    v_exp_f32 v83, v83
    v_smfmac_f32_32x32x32_bf16 v[64:79], a[92:95], v[136:143], v2
    s_waitcnt vmcnt(8)
    v_exp_f32 v84, v84
    v_exp_f32 v85, v85
    v_exp_f32 v86, v86
    v_exp_f32 v87, v87
    v_mfma_f32_32x32x16_bf16 v[96:111], a[36:39], a[12:15], v[96:111]
    buffer_load_dwordx4 a[80:83], v1, s[52:55], s58 offen sc1
    v_exp_f32 v88, v88
    v_exp_f32 v89, v89
    v_exp_f32 v90, v90
    v_exp_f32 v91, v91
    v_smfmac_f32_32x32x32_bf16 v[16:31], a[40:43], v[80:87], v2
    s_nop 0
    v_exp_f32 v92, v92
    v_exp_f32 v93, v93
    v_exp_f32 v94, v94
    v_exp_f32 v95, v95
    v_mfma_f32_32x32x16_bf16 v[112:127], a[32:35], a[16:19], 0
    v_exp_f32 v96, v96
    v_exp_f32 v97, v97
    v_exp_f32 v98, v98
    v_exp_f32 v99, v99
    v_smfmac_f32_32x32x32_bf16 v[16:31], a[44:47], v[88:95], v2
    v_exp_f32 v100, v100
    v_exp_f32 v101, v101
    v_exp_f32 v102, v102
    v_exp_f32 v103, v103
    v_mfma_f32_32x32x16_bf16 v[112:127], a[36:39], a[20:23], v[112:127]
    buffer_load_dwordx4 a[84:87], v1, s[52:55], s58 offen offset:1024 sc1
    v_exp_f32 v104, v104
    v_exp_f32 v105, v105
    v_exp_f32 v106, v106
    v_exp_f32 v107, v107
    v_smfmac_f32_32x32x32_bf16 v[32:47], a[40:43], v[96:103], v2
    s_nop 0
    v_exp_f32 v108, v108
    v_exp_f32 v109, v109
    v_exp_f32 v110, v110
    v_exp_f32 v111, v111
    v_mfma_f32_32x32x16_bf16 v[128:143], a[32:35], a[24:27], 0
    v_exp_f32 v112, v112
    v_exp_f32 v113, v113
    v_exp_f32 v114, v114
    v_exp_f32 v115, v115
    v_smfmac_f32_32x32x32_bf16 v[32:47], a[44:47], v[104:111], v2
    v_exp_f32 v116, v116
    v_exp_f32 v117, v117
    v_exp_f32 v118, v118
    v_exp_f32 v119, v119
    v_mfma_f32_32x32x16_bf16 v[128:143], a[36:39], a[28:31], v[128:143]
    buffer_load_dwordx4 a[88:91], v1, s[52:55], s58 offen offset:2048 sc1
    v_exp_f32 v120, v120
    v_exp_f32 v121, v121
    v_exp_f32 v122, v122
    v_exp_f32 v123, v123
    v_smfmac_f32_32x32x32_bf16 v[48:63], a[40:43], v[112:119], v2
    s_waitcnt vmcnt(9)
    v_exp_f32 v124, v124
    v_exp_f32 v125, v125
    v_exp_f32 v126, v126
    v_exp_f32 v127, v127
    v_mfma_f32_32x32x16_bf16 v[80:95], a[48:51], a[0:3], 0
    v_exp_f32 v128, v128
    v_exp_f32 v129, v129
    v_exp_f32 v130, v130
    v_exp_f32 v131, v131
    v_smfmac_f32_32x32x32_bf16 v[48:63], a[44:47], v[120:127], v2
    v_exp_f32 v132, v132
    v_exp_f32 v133, v133
    v_exp_f32 v134, v134
    v_exp_f32 v135, v135
    v_mfma_f32_32x32x16_bf16 v[80:95], a[52:55], a[4:7], v[80:95]
    buffer_load_dwordx4 a[92:95], v1, s[52:55], s58 offen offset:3072 sc1
    v_exp_f32 v136, v136
    v_exp_f32 v137, v137
    v_exp_f32 v138, v138
    v_exp_f32 v139, v139
    v_smfmac_f32_32x32x32_bf16 v[64:79], a[40:43], v[128:135], v2
    s_add_u32 s58, s58, 4096
    v_exp_f32 v140, v140
    v_exp_f32 v141, v141
    v_exp_f32 v142, v142
    v_exp_f32 v143, v143
    v_mfma_f32_32x32x16_bf16 v[96:111], a[48:51], a[8:11], 0
    v_exp_f32 v80, v80
    v_exp_f32 v81, v81
    v_exp_f32 v82, v82
    v_exp_f32 v83, v83
    v_smfmac_f32_32x32x32_bf16 v[64:79], a[44:47], v[136:143], v2
    s_waitcnt vmcnt(8)
    v_exp_f32 v84, v84
    v_exp_f32 v85, v85
    v_exp_f32 v86, v86
    v_exp_f32 v87, v87
    v_mfma_f32_32x32x16_bf16 v[96:111], a[52:55], a[12:15], v[96:111]
    v_exp_f32 v88, v88
    v_exp_f32 v89, v89
    v_exp_f32 v90, v90
    v_exp_f32 v91, v91
    v_smfmac_f32_32x32x32_bf16 v[16:31], a[56:59], v[80:87], v2
    s_nop 0
    s_nop 0
    v_exp_f32 v92, v92
    v_exp_f32 v93, v93
    v_exp_f32 v94, v94
    v_exp_f32 v95, v95
    v_mfma_f32_32x32x16_bf16 v[112:127], a[48:51], a[16:19], 0
    v_exp_f32 v96, v96
    v_exp_f32 v97, v97
    v_exp_f32 v98, v98
    v_exp_f32 v99, v99
    v_smfmac_f32_32x32x32_bf16 v[16:31], a[60:63], v[88:95], v2
    v_exp_f32 v100, v100
    v_exp_f32 v101, v101
    v_exp_f32 v102, v102
    v_exp_f32 v103, v103
    v_mfma_f32_32x32x16_bf16 v[112:127], a[52:55], a[20:23], v[112:127]
    v_exp_f32 v104, v104
    v_exp_f32 v105, v105
    v_exp_f32 v106, v106
    v_exp_f32 v107, v107
    v_smfmac_f32_32x32x32_bf16 v[32:47], a[56:59], v[96:103], v2
    s_nop 0
    s_nop 0
    v_exp_f32 v108, v108
    v_exp_f32 v109, v109
    v_exp_f32 v110, v110
    v_exp_f32 v111, v111
    s_barrier
    v_mfma_f32_32x32x16_bf16 v[128:143], a[48:51], a[24:27], 0
    v_exp_f32 v112, v112
    v_exp_f32 v113, v113
    v_exp_f32 v114, v114
    v_exp_f32 v115, v115
    v_smfmac_f32_32x32x32_bf16 v[32:47], a[60:63], v[104:111], v2
    v_exp_f32 v116, v116
    v_exp_f32 v117, v117
    v_exp_f32 v118, v118
    v_exp_f32 v119, v119
    v_mfma_f32_32x32x16_bf16 v[128:143], a[52:55], a[28:31], v[128:143]
    v_exp_f32 v120, v120
    v_exp_f32 v121, v121
    v_exp_f32 v122, v122
    v_exp_f32 v123, v123
    v_smfmac_f32_32x32x32_bf16 v[48:63], a[56:59], v[112:119], v2
    s_waitcnt vmcnt(6)
    s_nop 0
    v_exp_f32 v124, v124
    v_exp_f32 v125, v125
    v_exp_f32 v126, v126
    v_exp_f32 v127, v127
    v_mfma_f32_32x32x16_bf16 v[80:95], a[64:67], a[0:3], 0
    v_exp_f32 v128, v128
    v_exp_f32 v129, v129
    v_exp_f32 v130, v130
    v_exp_f32 v131, v131
    v_smfmac_f32_32x32x32_bf16 v[48:63], a[60:63], v[120:127], v2
    v_exp_f32 v132, v132
    v_exp_f32 v133, v133
    v_exp_f32 v134, v134
    v_exp_f32 v135, v135
    v_mfma_f32_32x32x16_bf16 v[80:95], a[68:71], a[4:7], v[80:95]
    v_exp_f32 v136, v136
    v_exp_f32 v137, v137
    v_exp_f32 v138, v138
    v_exp_f32 v139, v139
    v_smfmac_f32_32x32x32_bf16 v[64:79], a[56:59], v[128:135], v2
    s_waitcnt vmcnt(2)
    s_nop 0
    v_exp_f32 v140, v140
    v_exp_f32 v141, v141
    v_exp_f32 v142, v142
    v_exp_f32 v143, v143
    v_mfma_f32_32x32x16_bf16 v[96:111], a[80:83], a[0:3], 0
    v_exp_f32 v80, v80
    v_exp_f32 v81, v81
    v_exp_f32 v82, v82
    v_exp_f32 v83, v83
    v_smfmac_f32_32x32x32_bf16 v[64:79], a[60:63], v[136:143], v2
    v_exp_f32 v84, v84
    v_exp_f32 v85, v85
    v_exp_f32 v86, v86
    v_exp_f32 v87, v87
    v_mfma_f32_32x32x16_bf16 v[96:111], a[84:87], a[4:7], v[96:111]
    v_exp_f32 v88, v88
    v_exp_f32 v89, v89
    v_exp_f32 v90, v90
    v_exp_f32 v91, v91
    v_smfmac_f32_32x32x32_bf16 v[16:31], a[72:75], v[80:87], v2
    s_nop 0
    s_nop 0
    v_exp_f32 v92, v92
    v_exp_f32 v93, v93
    v_exp_f32 v94, v94
    v_exp_f32 v95, v95
    v_mfma_f32_32x32x16_bf16 v[112:127], a[64:67], a[8:11], 0
    v_exp_f32 v96, v96
    v_exp_f32 v97, v97
    v_exp_f32 v98, v98
    v_exp_f32 v99, v99
    v_smfmac_f32_32x32x32_bf16 v[16:31], a[76:79], v[88:95], v2
    s_waitcnt vmcnt(0)
    v_exp_f32 v100, v100
    v_exp_f32 v101, v101
    v_exp_f32 v102, v102
    v_exp_f32 v103, v103
    v_mfma_f32_32x32x16_bf16 v[112:127], a[68:71], a[12:15], v[112:127]
    v_exp_f32 v104, v104
    v_exp_f32 v105, v105
    v_exp_f32 v106, v106
    v_exp_f32 v107, v107
    v_smfmac_f32_32x32x32_bf16 v[16:31], a[88:91], v[96:103], v2
    s_nop 0
    s_nop 0
    v_exp_f32 v108, v108
    v_exp_f32 v109, v109
    v_exp_f32 v110, v110
    v_exp_f32 v111, v111
    v_mfma_f32_32x32x16_bf16 v[128:143], a[80:83], a[8:11], 0
    v_exp_f32 v112, v112
    v_exp_f32 v113, v113
    v_exp_f32 v114, v114
    v_exp_f32 v115, v115
    v_smfmac_f32_32x32x32_bf16 v[16:31], a[92:95], v[104:111], v2
    v_exp_f32 v116, v116
    v_exp_f32 v117, v117
    v_exp_f32 v118, v118
    v_exp_f32 v119, v119
    v_mfma_f32_32x32x16_bf16 v[128:143], a[84:87], a[12:15], v[128:143]
    v_exp_f32 v120, v120
    v_exp_f32 v121, v121
    v_exp_f32 v122, v122
    v_exp_f32 v123, v123
    v_smfmac_f32_32x32x32_bf16 v[32:47], a[72:75], v[112:119], v2
    s_nop 0
    s_nop 0
    v_exp_f32 v124, v124
    v_exp_f32 v125, v125
    v_exp_f32 v126, v126
    v_exp_f32 v127, v127
    v_mfma_f32_32x32x16_bf16 v[80:95], a[64:67], a[16:19], 0
    ds_write_b128 v144, v[16:19] offset:0
    v_exp_f32 v128, v128
    v_exp_f32 v129, v129
    v_exp_f32 v130, v130
    v_exp_f32 v131, v131
    v_smfmac_f32_32x32x32_bf16 v[32:47], a[76:79], v[120:127], v2
    v_exp_f32 v132, v132
    v_exp_f32 v133, v133
    v_exp_f32 v134, v134
    v_exp_f32 v135, v135
    v_mfma_f32_32x32x16_bf16 v[80:95], a[68:71], a[20:23], v[80:95]
    ds_write_b128 v144, v[20:23] offset:1024
    v_exp_f32 v136, v136
    v_exp_f32 v137, v137
    v_exp_f32 v138, v138
    v_exp_f32 v139, v139
    v_smfmac_f32_32x32x32_bf16 v[32:47], a[88:91], v[128:135], v2
    s_nop 0
    v_exp_f32 v140, v140
    v_exp_f32 v141, v141
    v_exp_f32 v142, v142
    v_exp_f32 v143, v143
    v_mfma_f32_32x32x16_bf16 v[96:111], a[80:83], a[16:19], 0
    ds_write_b128 v144, v[24:27] offset:2048
    v_exp_f32 v80, v80
    v_exp_f32 v81, v81
    v_exp_f32 v82, v82
    v_exp_f32 v83, v83
    v_smfmac_f32_32x32x32_bf16 v[32:47], a[92:95], v[136:143], v2
    v_exp_f32 v84, v84
    v_exp_f32 v85, v85
    v_exp_f32 v86, v86
    v_exp_f32 v87, v87
    v_mfma_f32_32x32x16_bf16 v[96:111], a[84:87], a[20:23], v[96:111]
    ds_write_b128 v144, v[28:31] offset:3072
    v_exp_f32 v88, v88
    v_exp_f32 v89, v89
    v_exp_f32 v90, v90
    v_exp_f32 v91, v91
    v_smfmac_f32_32x32x32_bf16 v[48:63], a[72:75], v[80:87], v2
    s_nop 0
    v_exp_f32 v92, v92
    v_exp_f32 v93, v93
    v_exp_f32 v94, v94
    v_exp_f32 v95, v95
    v_mfma_f32_32x32x16_bf16 v[112:127], a[64:67], a[24:27], 0
    ds_write_b128 v145, v[32:35] offset:0
    v_exp_f32 v96, v96
    v_exp_f32 v97, v97
    v_exp_f32 v98, v98
    v_exp_f32 v99, v99
    v_smfmac_f32_32x32x32_bf16 v[48:63], a[76:79], v[88:95], v2
    ds_write_b128 v145, v[36:39] offset:1024
    v_exp_f32 v100, v100
    v_exp_f32 v101, v101
    v_exp_f32 v102, v102
    v_exp_f32 v103, v103
    v_mfma_f32_32x32x16_bf16 v[112:127], a[68:71], a[28:31], v[112:127]
    ds_write_b128 v145, v[40:43] offset:2048
    v_exp_f32 v104, v104
    v_exp_f32 v105, v105
    v_exp_f32 v106, v106
    v_exp_f32 v107, v107
    v_smfmac_f32_32x32x32_bf16 v[48:63], a[88:91], v[96:103], v2
    ds_write_b128 v145, v[44:47] offset:3072
    v_exp_f32 v108, v108
    v_exp_f32 v109, v109
    v_exp_f32 v110, v110
    v_exp_f32 v111, v111
    v_mfma_f32_32x32x16_bf16 v[128:143], a[80:83], a[24:27], 0
    v_exp_f32 v112, v112
    v_exp_f32 v113, v113
    v_exp_f32 v114, v114
    v_exp_f32 v115, v115
    v_smfmac_f32_32x32x32_bf16 v[48:63], a[92:95], v[104:111], v2
    v_exp_f32 v116, v116
    v_exp_f32 v117, v117
    v_exp_f32 v118, v118
    v_exp_f32 v119, v119
    v_mfma_f32_32x32x16_bf16 v[128:143], a[84:87], a[28:31], v[128:143]
    v_exp_f32 v120, v120
    v_exp_f32 v121, v121
    v_exp_f32 v122, v122
    v_exp_f32 v123, v123
    v_smfmac_f32_32x32x32_bf16 v[64:79], a[72:75], v[112:119], v2
    s_nop 0
    s_nop 0
    v_exp_f32 v124, v124
    v_exp_f32 v125, v125
    v_exp_f32 v126, v126
    v_exp_f32 v127, v127
    ds_write_b128 v146, v[48:51] offset:0
    ds_write_b128 v146, v[52:55] offset:1024
    ds_write_b128 v146, v[56:59] offset:2048
    ds_write_b128 v146, v[60:63] offset:3072
    v_exp_f32 v128, v128
    v_exp_f32 v129, v129
    v_exp_f32 v130, v130
    v_exp_f32 v131, v131
    v_smfmac_f32_32x32x32_bf16 v[64:79], a[76:79], v[120:127], v2
    v_exp_f32 v132, v132
    v_exp_f32 v133, v133
    v_exp_f32 v134, v134
    v_exp_f32 v135, v135
    s_waitcnt lgkmcnt(0)
    s_barrier
    ds_read_b128 v[16:19], v147 offset:0
    ds_read_b128 v[20:23], v147 offset:4096
    ds_read_b128 v[24:27], v147 offset:8192
    ds_read_b128 v[28:31], v147 offset:1024
    ds_read_b128 v[32:35], v147 offset:5120
    ds_read_b128 v[36:39], v147 offset:9216
    v_exp_f32 v136, v136
    v_exp_f32 v137, v137
    v_exp_f32 v138, v138
    v_exp_f32 v139, v139
    v_smfmac_f32_32x32x32_bf16 v[64:79], a[88:91], v[128:135], v2
    ds_read_b128 v[40:43], v147 offset:2048
    ds_read_b128 v[44:47], v147 offset:6144
    ds_read_b128 v[48:51], v147 offset:10240
    ds_read_b128 v[52:55], v147 offset:3072
    ds_read_b128 v[56:59], v147 offset:7168
    ds_read_b128 v[60:63], v147 offset:11264
    v_exp_f32 v140, v140
    v_exp_f32 v141, v141
    v_exp_f32 v142, v142
    v_exp_f32 v143, v143
    s_setprio 1
    v_mov_b32 v102, 0
    v_smfmac_f32_32x32x32_bf16 v[64:79], a[92:95], v[136:143], v2
    v_mov_b32 v103, 0
    s_mov_b32 s62, 0x21800000
    s_mov_b32 s63, 0x7b800000
    s_waitcnt lgkmcnt(9)
    v_add_f32 v16, v16, v20
    v_add_f32 v17, v17, v21
    v_add_f32 v18, v18, v22
    v_add_f32 v19, v19, v23
    v_add_f32 v16, v16, v24
    v_add_f32 v17, v17, v25
    v_add_f32 v18, v18, v26
    v_add_f32 v19, v19, v27
    s_waitcnt lgkmcnt(6)
    v_add_f32 v28, v28, v32
    v_add_f32 v29, v29, v33
    v_add_f32 v30, v30, v34
    v_add_f32 v31, v31, v35
    v_add_f32 v28, v28, v36
    v_add_f32 v29, v29, v37
    v_add_f32 v30, v30, v38
    v_add_f32 v31, v31, v39
    s_waitcnt lgkmcnt(3)
    v_add_f32 v40, v40, v44
    v_add_f32 v41, v41, v45
    v_add_f32 v42, v42, v46
    v_add_f32 v43, v43, v47
    v_add_f32 v40, v40, v48
    v_add_f32 v41, v41, v49
    v_add_f32 v42, v42, v50
    v_add_f32 v43, v43, v51
    s_waitcnt lgkmcnt(0)
    v_add_f32 v52, v52, v56
    v_add_f32 v53, v53, v57
    v_add_f32 v54, v54, v58
    v_add_f32 v55, v55, v59
    v_add_f32 v52, v52, v60
    v_add_f32 v53, v53, v61
    v_add_f32 v54, v54, v62
    v_add_f32 v55, v55, v63
    v_add_f32 v76, v76, v52
    v_add_f32 v77, v77, v53
    v_add_f32 v78, v78, v54
    v_add_f32 v79, v79, v55
    v_add_f32 v72, v72, v40
    v_add_f32 v73, v73, v41
    v_add_f32 v74, v74, v42
    v_add_f32 v75, v75, v43
    v_add_f32 v68, v68, v28
    v_add_f32 v69, v69, v29
    v_add_f32 v70, v70, v30
    v_add_f32 v71, v71, v31
    v_add_f32 v64, v64, v16
    v_add_f32 v65, v65, v17
    v_add_f32 v66, v66, v18
    v_add_f32 v67, v67, v19
    s_mov_b32 s59, 0
C_FIN:
    v_mov_b32 v6, v76
    v_mov_b32 v7, v76
    v_maximum3_f32 v8, abs(v76), abs(v77), abs(v78)
    v_maximum3_f32 v9, abs(v79), abs(v72), abs(v73)
    v_permlane32_swap_b32 v6, v7
    v_rcp_f32 v6, v7
    v_mov_b32 v5, 163824
    v_mul_f32 v6, v6, v14
    v_mul_f32 v112, v6, v64
    v_mul_f32 v113, v6, v65
    v_mul_f32 v114, v6, v66
    v_mul_f32 v115, v6, v67
    v_mul_f32 v116, v6, v68
    v_mul_f32 v117, v6, v69
    v_mul_f32 v118, v6, v70
    v_mul_f32 v119, v6, v71
    v_cvt_pk_bf16_f32 v96, v112, v113
    v_cvt_pk_bf16_f32 v97, v114, v115
    v_cvt_pk_bf16_f32 v98, v116, v117
    v_cvt_pk_bf16_f32 v99, v118, v119
    buffer_store_dwordx4 v[96:99], v13, s[52:55], s46 offen sc1
    v_mul_f32 v120, v6, v72
    v_mul_f32 v121, v6, v73
    v_mul_f32 v122, v6, v74
    v_mul_f32 v123, v6, v75
    v_mul_f32 v124, v6, v76
    v_mul_f32 v125, v6, v77
    v_mul_f32 v126, v6, v78
    v_mul_f32 v127, v6, v79
    v_cvt_pk_bf16_f32 v100, v120, v121
    v_cvt_pk_bf16_f32 v101, v122, v123
    s_mov_b32 exec_hi, 0
    v_cvt_pk_bf16_f32 v102, v124, v125
    v_cvt_pk_bf16_f32 v103, v126, v127
    s_mov_b32 exec_hi, -1
    buffer_store_dwordx4 v[100:103], v13, s[52:55], s46 offen offset:1024 sc1
    v_maximum3_f32 v8, v8, abs(v74), abs(v75)
    v_maximum3_f32 v9, v9, abs(v68), abs(v69)
    v_maximum3_f32 v8, v8, abs(v70), abs(v71)
    v_maximum3_f32 v9, v9, abs(v64), abs(v65)
    v_maximum3_f32 v8, v8, abs(v66), abs(v67)
    v_cmp_nge_f32 vcc, v7, s62
    v_maximum3_f32 v8, v8, v9, v9
    s_cmp_lg_u32 s59, 0
    v_cmp_nlt_f32 s[64:65], v8, s63
    s_cbranch_scc1 C_CHKD
    s_or_b64 vcc, vcc, s[64:65]
    s_cbranch_scc1 C_FALLBACK
C_CHKD:
    s_cmp_eq_u32 s27, 3
    s_cbranch_scc0 C_NOCLR
    ds_write_b32 v5, v3
C_NOCLR:
    s_waitcnt lgkmcnt(0)
    s_barrier
    s_mul_i32 s60, s92, 28672
    s_add_u32 s60, s60, 57344
    s_lshl_b32 s61, s92, 6
    v_mov_b32 v1, v5
    v_mov_b32 v5, 0
    v_bfe_u32 v8, v0, 4, 1
    v_lshl_add_u32 v5, v8, 5, v5
    v_and_b32 v8, 3, v0
    v_lshl_add_u32 v5, v8, 3, v5
    v_bfe_u32 v8, v0, 2, 1
    v_lshrrev_b32 v9, 6, v5
    v_lshl_add_u32 v8, v8, 1, v9
    v_bfe_u32 v9, v0, 3, 1
    v_xor_b32 v8, v8, v9
    v_and_b32 v5, 63, v5
    v_lshl_add_u32 v5, v8, 6, v5
    v_lshrrev_b32 v8, 5, v0
    v_lshl_add_u32 v8, v8, 1, v9
    v_lshl_add_u32 v4, v8, 8, v5
    v_add_u32 v4, s60, v4
    v_xor_b32 v4, s61, v4
    v_xor_b32 v5, 64, v4
    v_lshrrev_b32 v8, 5, v0
    v_lshlrev_b32 v8, 9, v8
    v_sub_u32 v6, v4, v8
    v_sub_u32 v7, v5, v8
    s_lshl_b32 s60, s27, 13
    s_add_u32 s60, s60, 114688
    v_add_u32 v8, s60, v13
    s_lshl_b32 s60, s27, 12
    s_add_u32 s60, s60, 147456
    v_add_u32 v9, s60, v13
    v_xor_b32 v10, 8192, v9
    s_lshl_b32 s60, s30, 1
    s_add_u32 s60, s60, s93
    v_and_b32 v11, 31, v0
    v_lshrrev_b32 v12, 5, v0
    s_lshl_b32 s61, s92, 2
    v_add_u32 v12, s61, v12
    v_and_b32 v15, 7, v0
    v_xor_b32 v12, v12, v15
    s_lshl_b32 s61, s93, 12
    s_add_u32 s61, s61, 114688
    v_lshl_add_u32 v11, v11, 7, s61
    v_lshl_add_u32 v11, v12, 4, v11
    v_xor_b32 v2, 32, v11
    v_lshrrev_b32 v12, 3, v0
    v_xor_b32 v15, v15, v12
    s_lshl_b32 s61, s30, 6
    s_lshl_b32 s63, s27, 4
    s_add_u32 s61, s61, s63
    v_add_u32 v12, s61, v12
    v_mul_u32_u24 v12, 896, v12
    v_lshl_add_u32 v15, v15, 4, v12
    s_mul_i32 s60, s60, 69632
    s_lshl_b32 s61, s92, 14
    s_add_u32 s60, s60, s61
    s_add_u32 s60, s60, 8421376
    s_and_b32 s61, s30, 0xfe
    s_lshl_b32 s61, s61, 10
    s_add_u32 s61, s61, 5308416
    s_lshl_b32 s62, s31, 7
    s_add_u32 s63, s62, 7168
    s_mov_b32 s36, s18
    s_mov_b32 s37, s19
    s_mov_b32 s38, 1835008
    s_mov_b32 s39, 0x20000
    s_lshl_b32 s64, s24, 4
    s_add_u32 s64, s64, s28
    s_lshl_b32 s64, s64, 7
    s_add_u32 s64, s64, 5308416
    v_mov_b32 v12, 1
    s_mov_b64 exec, 1
    s_waitcnt vmcnt(0)
    ds_add_rtn_u32 v14, v1, v12
    s_waitcnt lgkmcnt(0)
    v_readfirstlane_b32 s69, v14
    s_nop 0
    s_cmp_eq_u32 s69, 3
    s_mov_b64 exec, -1
    s_cbranch_scc0 C_NOSIG
    s_mov_b32 exec_hi, 0
    v_lshlrev_b32 v14, 2, v0
    v_mov_b32 v12, s87
    buffer_store_dword v12, v14, s[52:55], s64 offen sc1
    s_mov_b32 exec_hi, -1
C_NOSIG:
    s_mov_b64 exec, -1
    s_cmp_ge_u32 s32, 28
    s_cbranch_scc1 C_EXIT
    v_lshlrev_b32 v14, 7, v0
    s_cmp_eq_u32 s27, 0
    s_cbranch_scc0 C_OBD
    s_mov_b64 exec, 65535
    s_mov_b32 s68, 200000
    s_mov_b64 vcc, exec
POLLS_OB:
    s_mov_b64 exec, vcc
    s_sleep 8
POLL_OB:
    buffer_load_dword v12, v14, s[52:55], s61 offen sc1
    s_sub_u32 s68, s68, 1
    s_cbranch_scc1 POLLX_OB
    s_waitcnt vmcnt(0)
    v_cmp_ne_u32 vcc, s87, v12
    s_cbranch_vccnz POLLS_OB
POLLX_OB:
    s_mov_b64 exec, -1
C_OBD:
    s_barrier
    buffer_load_dwordx4 a[0:3], v13, s[52:55], s60 offen offset:0 sc1
    buffer_load_dwordx4 a[4:7], v13, s[52:55], s60 offen offset:1024 sc1
    buffer_load_dwordx4 a[8:11], v13, s[52:55], s60 offen offset:2048 sc1
    buffer_load_dwordx4 a[12:15], v13, s[52:55], s60 offen offset:3072 sc1
    s_add_u32 s60, s60, 4096
    buffer_load_dwordx4 a[16:19], v13, s[52:55], s60 offen offset:0 sc1
    buffer_load_dwordx4 a[20:23], v13, s[52:55], s60 offen offset:1024 sc1
    buffer_load_dwordx4 a[24:27], v13, s[52:55], s60 offen offset:2048 sc1
    buffer_load_dwordx4 a[28:31], v13, s[52:55], s60 offen offset:3072 sc1
    s_add_u32 s60, s60, 4096
    buffer_load_dwordx4 a[32:35], v13, s[52:55], s60 offen offset:0 sc1
    buffer_load_dwordx4 a[36:39], v13, s[52:55], s60 offen offset:1024 sc1
    ds_read_b128 v[16:19], v8 offset:0
    ds_read_b128 v[20:23], v8 offset:1024
    ds_read_b128 v[24:27], v8 offset:2048
    ds_read_b128 v[28:31], v8 offset:3072
    ds_read_b128 v[32:35], v8 offset:4096
    ds_read_b128 v[36:39], v8 offset:5120
    ds_read_b128 v[40:43], v8 offset:6144
    ds_read_b128 v[44:47], v8 offset:7168
    ds_read_b64_tr_b16 v[48:49], v4 offset:0
    ds_read_b64_tr_b16 v[50:51], v4 offset:1024
    ds_read_b64_tr_b16 v[52:53], v5 offset:0
    ds_read_b64_tr_b16 v[54:55], v5 offset:1024
    buffer_load_dwordx4 a[40:43], v13, s[52:55], s60 offen offset:2048 sc1
    s_waitcnt vmcnt(10) lgkmcnt(2)
    v_mfma_f32_32x32x16_bf16 v[16:31], v[48:51], a[0:3], v[16:31]
    ds_read_b64_tr_b16 v[56:57], v4 offset:2048
    ds_read_b64_tr_b16 v[58:59], v4 offset:3072
    s_waitcnt lgkmcnt(2)
    v_mfma_f32_32x32x16_bf16 v[32:47], v[52:55], a[0:3], v[32:47]
    ds_read_b64_tr_b16 v[60:61], v5 offset:2048
    ds_read_b64_tr_b16 v[62:63], v5 offset:3072
    buffer_load_dwordx4 a[44:47], v13, s[52:55], s60 offen offset:3072 sc1
    s_add_u32 s60, s60, 4096
    s_waitcnt vmcnt(10) lgkmcnt(2)
    v_mfma_f32_32x32x16_bf16 v[16:31], v[56:59], a[4:7], v[16:31]
    ds_read_b64_tr_b16 v[48:49], v4 offset:3584
    ds_read_b64_tr_b16 v[50:51], v4 offset:4608
    s_waitcnt lgkmcnt(2)
    v_mfma_f32_32x32x16_bf16 v[32:47], v[60:63], a[4:7], v[32:47]
    ds_read_b64_tr_b16 v[52:53], v5 offset:3584
    ds_read_b64_tr_b16 v[54:55], v5 offset:4608
    buffer_load_dwordx4 a[48:51], v13, s[52:55], s60 offen offset:0 sc1
    s_waitcnt vmcnt(10) lgkmcnt(2)
    v_mfma_f32_32x32x16_bf16 v[16:31], v[48:51], a[8:11], v[16:31]
    ds_read_b64_tr_b16 v[56:57], v4 offset:5632
    ds_read_b64_tr_b16 v[58:59], v4 offset:6656
    s_waitcnt lgkmcnt(2)
    v_mfma_f32_32x32x16_bf16 v[32:47], v[52:55], a[8:11], v[32:47]
    ds_read_b64_tr_b16 v[60:61], v5 offset:5632
    ds_read_b64_tr_b16 v[62:63], v5 offset:6656
    buffer_load_dwordx4 a[52:55], v13, s[52:55], s60 offen offset:1024 sc1
    s_waitcnt vmcnt(10) lgkmcnt(2)
    v_mfma_f32_32x32x16_bf16 v[16:31], v[56:59], a[12:15], v[16:31]
    ds_read_b64_tr_b16 v[48:49], v4 offset:7168
    ds_read_b64_tr_b16 v[50:51], v4 offset:8192
    s_waitcnt lgkmcnt(2)
    v_mfma_f32_32x32x16_bf16 v[32:47], v[60:63], a[12:15], v[32:47]
    ds_read_b64_tr_b16 v[52:53], v5 offset:7168
    ds_read_b64_tr_b16 v[54:55], v5 offset:8192
    buffer_load_dwordx4 a[56:59], v13, s[52:55], s60 offen offset:2048 sc1
    s_waitcnt vmcnt(10) lgkmcnt(2)
    v_mfma_f32_32x32x16_bf16 v[16:31], v[48:51], a[16:19], v[16:31]
    ds_read_b64_tr_b16 v[56:57], v4 offset:9216
    ds_read_b64_tr_b16 v[58:59], v4 offset:10240
    s_waitcnt lgkmcnt(2)
    v_mfma_f32_32x32x16_bf16 v[32:47], v[52:55], a[16:19], v[32:47]
    ds_read_b64_tr_b16 v[60:61], v5 offset:9216
    ds_read_b64_tr_b16 v[62:63], v5 offset:10240
    buffer_load_dwordx4 a[60:63], v13, s[52:55], s60 offen offset:3072 sc1
    s_waitcnt vmcnt(10) lgkmcnt(2)
    v_mfma_f32_32x32x16_bf16 v[16:31], v[56:59], a[20:23], v[16:31]
    ds_read_b64_tr_b16 v[48:49], v4 offset:10752
    ds_read_b64_tr_b16 v[50:51], v4 offset:11776
    s_waitcnt lgkmcnt(2)
    v_mfma_f32_32x32x16_bf16 v[32:47], v[60:63], a[20:23], v[32:47]
    ds_read_b64_tr_b16 v[52:53], v5 offset:10752
    ds_read_b64_tr_b16 v[54:55], v5 offset:11776
    s_waitcnt vmcnt(9) lgkmcnt(2)
    v_mfma_f32_32x32x16_bf16 v[16:31], v[48:51], a[24:27], v[16:31]
    ds_read_b64_tr_b16 v[56:57], v4 offset:12800
    ds_read_b64_tr_b16 v[58:59], v4 offset:13824
    s_waitcnt lgkmcnt(2)
    v_mfma_f32_32x32x16_bf16 v[32:47], v[52:55], a[24:27], v[32:47]
    ds_read_b64_tr_b16 v[60:61], v5 offset:12800
    ds_read_b64_tr_b16 v[62:63], v5 offset:13824
    s_waitcnt vmcnt(8) lgkmcnt(2)
    v_mfma_f32_32x32x16_bf16 v[16:31], v[56:59], a[28:31], v[16:31]
    ds_read_b64_tr_b16 v[48:49], v4 offset:14336
    ds_read_b64_tr_b16 v[50:51], v4 offset:15360
    s_waitcnt lgkmcnt(2)
    v_mfma_f32_32x32x16_bf16 v[32:47], v[60:63], a[28:31], v[32:47]
    ds_read_b64_tr_b16 v[52:53], v5 offset:14336
    ds_read_b64_tr_b16 v[54:55], v5 offset:15360
    s_waitcnt vmcnt(7) lgkmcnt(2)
    v_mfma_f32_32x32x16_bf16 v[16:31], v[48:51], a[32:35], v[16:31]
    ds_read_b64_tr_b16 v[56:57], v4 offset:16384
    ds_read_b64_tr_b16 v[58:59], v4 offset:17408
    s_waitcnt lgkmcnt(2)
    v_mfma_f32_32x32x16_bf16 v[32:47], v[52:55], a[32:35], v[32:47]
    ds_read_b64_tr_b16 v[60:61], v5 offset:16384
    ds_read_b64_tr_b16 v[62:63], v5 offset:17408
    s_waitcnt vmcnt(6) lgkmcnt(2)
    v_mfma_f32_32x32x16_bf16 v[16:31], v[56:59], a[36:39], v[16:31]
    ds_read_b64_tr_b16 v[48:49], v4 offset:17920
    ds_read_b64_tr_b16 v[50:51], v4 offset:18944
    s_waitcnt lgkmcnt(2)
    v_mfma_f32_32x32x16_bf16 v[32:47], v[60:63], a[36:39], v[32:47]
    ds_read_b64_tr_b16 v[52:53], v5 offset:17920
    ds_read_b64_tr_b16 v[54:55], v5 offset:18944
    s_waitcnt vmcnt(5) lgkmcnt(2)
    v_mfma_f32_32x32x16_bf16 v[16:31], v[48:51], a[40:43], v[16:31]
    ds_read_b64_tr_b16 v[56:57], v4 offset:19968
    ds_read_b64_tr_b16 v[58:59], v4 offset:20992
    s_waitcnt lgkmcnt(2)
    v_mfma_f32_32x32x16_bf16 v[32:47], v[52:55], a[40:43], v[32:47]
    ds_read_b64_tr_b16 v[60:61], v5 offset:19968
    ds_read_b64_tr_b16 v[62:63], v5 offset:20992
    s_waitcnt vmcnt(4) lgkmcnt(2)
    v_mfma_f32_32x32x16_bf16 v[16:31], v[56:59], a[44:47], v[16:31]
    ds_read_b64_tr_b16 v[48:49], v4 offset:21504
    ds_read_b64_tr_b16 v[50:51], v4 offset:22528
    s_waitcnt lgkmcnt(2)
    v_mfma_f32_32x32x16_bf16 v[32:47], v[60:63], a[44:47], v[32:47]
    ds_read_b64_tr_b16 v[52:53], v5 offset:21504
    ds_read_b64_tr_b16 v[54:55], v5 offset:22528
    s_waitcnt vmcnt(3) lgkmcnt(2)
    v_mfma_f32_32x32x16_bf16 v[16:31], v[48:51], a[48:51], v[16:31]
    ds_read_b64_tr_b16 v[56:57], v4 offset:23552
    ds_read_b64_tr_b16 v[58:59], v4 offset:24576
    s_waitcnt lgkmcnt(2)
    v_mfma_f32_32x32x16_bf16 v[32:47], v[52:55], a[48:51], v[32:47]
    ds_read_b64_tr_b16 v[60:61], v5 offset:23552
    ds_read_b64_tr_b16 v[62:63], v5 offset:24576
    s_waitcnt vmcnt(2) lgkmcnt(2)
    v_mfma_f32_32x32x16_bf16 v[16:31], v[56:59], a[52:55], v[16:31]
    ds_read_b64_tr_b16 v[48:49], v4 offset:25088
    ds_read_b64_tr_b16 v[50:51], v4 offset:26112
    s_waitcnt lgkmcnt(2)
    v_mfma_f32_32x32x16_bf16 v[32:47], v[60:63], a[52:55], v[32:47]
    ds_read_b64_tr_b16 v[52:53], v5 offset:25088
    ds_read_b64_tr_b16 v[54:55], v5 offset:26112
    s_waitcnt vmcnt(1) lgkmcnt(2)
    v_mfma_f32_32x32x16_bf16 v[16:31], v[48:51], a[56:59], v[16:31]
    ds_read_b64_tr_b16 v[56:57], v4 offset:27136
    ds_read_b64_tr_b16 v[58:59], v6 offset:28160
    s_waitcnt lgkmcnt(2)
    v_mfma_f32_32x32x16_bf16 v[32:47], v[52:55], a[56:59], v[32:47]
    ds_read_b64_tr_b16 v[60:61], v5 offset:27136
    ds_read_b64_tr_b16 v[62:63], v7 offset:28160
    s_waitcnt vmcnt(0) lgkmcnt(2)
    v_mfma_f32_32x32x16_bf16 v[16:31], v[56:59], a[60:63], v[16:31]
    s_waitcnt lgkmcnt(0)
    v_mfma_f32_32x32x16_bf16 v[32:47], v[60:63], a[60:63], v[32:47]
    v_mov_b32 v12, v2
    s_lshl_b32 s64, s27, 11
    s_add_u32 s64, s64, 114688
    v_add_u32 v14, s64, v13
    s_nop 7
    ds_write_b128 v9, v[32:35] offset:0
    ds_write_b128 v9, v[36:39] offset:1024
    ds_write_b128 v9, v[40:43] offset:2048
    ds_write_b128 v9, v[44:47] offset:3072
    s_waitcnt lgkmcnt(0)
    s_barrier
    ds_read_b128 v[32:35], v10 offset:0
    ds_read_b128 v[36:39], v10 offset:1024
    ds_read_b128 v[40:43], v10 offset:2048
    ds_read_b128 v[44:47], v10 offset:3072
    s_waitcnt lgkmcnt(3)
    v_add_f32 v16, v16, v32
    v_add_f32 v17, v17, v33
    v_add_f32 v18, v18, v34
    v_add_f32 v19, v19, v35
    s_waitcnt lgkmcnt(2)
    v_add_f32 v20, v20, v36
    v_add_f32 v21, v21, v37
    v_add_f32 v22, v22, v38
    v_add_f32 v23, v23, v39
    v_cvt_pk_bf16_f32 v48, v16, v17
    v_cvt_pk_bf16_f32 v49, v18, v19
    v_cvt_pk_bf16_f32 v50, v20, v21
    v_cvt_pk_bf16_f32 v51, v22, v23
    s_nop 1
    v_permlane32_swap_b32 v48, v50
    v_permlane32_swap_b32 v49, v51
    ds_write_b128 v11, v[48:51]
    s_waitcnt lgkmcnt(2)
    v_add_f32 v24, v24, v40
    v_add_f32 v25, v25, v41
    v_add_f32 v26, v26, v42
    v_add_f32 v27, v27, v43
    s_waitcnt lgkmcnt(1)
    v_add_f32 v28, v28, v44
    v_add_f32 v29, v29, v45
    v_add_f32 v30, v30, v46
    v_add_f32 v31, v31, v47
    v_cvt_pk_bf16_f32 v52, v24, v25
    v_cvt_pk_bf16_f32 v53, v26, v27
    v_cvt_pk_bf16_f32 v54, v28, v29
    v_cvt_pk_bf16_f32 v55, v30, v31
    s_nop 1
    v_permlane32_swap_b32 v52, v54
    v_permlane32_swap_b32 v53, v55
    ds_write_b128 v12, v[52:55]
    s_waitcnt lgkmcnt(0)
    s_barrier
    ds_read_b128 v[16:19], v14
    ds_read_b128 v[20:23], v14 offset:1024
    s_waitcnt lgkmcnt(1)
    buffer_store_dwordx4 v[16:19], v15, s[36:39], s62 offen sc1
    s_waitcnt lgkmcnt(0)
    buffer_store_dwordx4 v[20:23], v15, s[36:39], s63 offen sc1
C_EXIT:
    s_endpgm
C_FALLBACK:
    s_mov_b32 s58, 0
    s_mov_b32 s59, 0
    v_mov_b32 v8, 0xff800000
C_FB1:
    buffer_load_dwordx4 a[32:35], v4, s[52:55], s58 offen sc1
    buffer_load_dwordx4 a[36:39], v4, s[52:55], s58 offen offset:1024 sc1
    s_waitcnt vmcnt(0)
    v_mfma_f32_32x32x16_bf16 v[80:95], a[32:35], a[24:27], 0
    v_mfma_f32_32x32x16_bf16 v[80:95], a[36:39], a[28:31], v[80:95]
    s_add_u32 s58, s58, 4096
    s_add_u32 s59, s59, 1
    s_and_b32 s61, s59, 15
    s_cselect_b32 s61, 0, 4096
    s_add_u32 s58, s58, s61
    s_nop 15
    s_nop 15
    v_max3_f32 v8, v8, v80, v81
    v_max3_f32 v8, v8, v82, v83
    v_max3_f32 v8, v8, v84, v85
    v_max3_f32 v8, v8, v86, v87
    v_max3_f32 v8, v8, v88, v89
    v_max3_f32 v8, v8, v90, v91
    v_max3_f32 v8, v8, v92, v93
    v_max3_f32 v8, v8, v94, v95
    s_cmp_lt_u32 s59, 64
    s_cbranch_scc1 C_FB1
    v_mov_b32 v9, v8
    s_nop 1
    v_permlane32_swap_b32 v8, v9
    v_max_f32 v8, v8, v9
    v_and_b32 v9, 0xffff0000, v8
    v_sub_f32 v8, v8, v9
    v_and_b32 v10, 0xffff0000, v8
    v_sub_f32 v8, v8, v10
    v_cvt_pk_bf16_f32 v9, -v9, -v10
    v_cvt_pk_bf16_f32 v8, -v8, 0
    s_mov_b32 exec_lo, 0
    v_accvgpr_write_b32 a30, v9
    v_accvgpr_write_b32 a31, v8
    s_mov_b32 exec_lo, -1
    v_mov_b32 v64, 0
    v_mov_b32 v65, 0
    v_mov_b32 v66, 0
    v_mov_b32 v67, 0
    v_mov_b32 v68, 0
    v_mov_b32 v69, 0
    v_mov_b32 v70, 0
    v_mov_b32 v71, 0
    v_mov_b32 v72, 0
    v_mov_b32 v73, 0
    v_mov_b32 v74, 0
    v_mov_b32 v75, 0
    v_mov_b32 v76, 0
    v_mov_b32 v77, 0
    v_mov_b32 v78, 0
    v_mov_b32 v79, 0
    s_mov_b32 s58, 0
    s_mov_b32 s59, 0
C_FB2:
    buffer_load_dwordx4 a[32:35], v4, s[52:55], s58 offen sc1
    buffer_load_dwordx4 a[36:39], v4, s[52:55], s58 offen offset:1024 sc1
    buffer_load_dwordx4 a[40:43], v4, s[52:55], s58 offen offset:2048 sc1
    buffer_load_dwordx4 a[44:47], v4, s[52:55], s58 offen offset:3072 sc1
    s_waitcnt vmcnt(0)
    v_mfma_f32_32x32x16_bf16 v[80:95], a[32:35], a[24:27], 0
    v_mfma_f32_32x32x16_bf16 v[80:95], a[36:39], a[28:31], v[80:95]
    s_add_u32 s58, s58, 4096
    s_add_u32 s59, s59, 1
    s_and_b32 s61, s59, 15
    s_cselect_b32 s61, 0, 4096
    s_add_u32 s58, s58, s61
    s_nop 15
    s_nop 15
    v_exp_f32 v80, v80
    v_exp_f32 v81, v81
    v_exp_f32 v82, v82
    v_exp_f32 v83, v83
    v_exp_f32 v84, v84
    v_exp_f32 v85, v85
    v_exp_f32 v86, v86
    v_exp_f32 v87, v87
    v_exp_f32 v88, v88
    v_exp_f32 v89, v89
    v_exp_f32 v90, v90
    v_exp_f32 v91, v91
    v_exp_f32 v92, v92
    v_exp_f32 v93, v93
    v_exp_f32 v94, v94
    v_exp_f32 v95, v95
    s_nop 1
    v_smfmac_f32_32x32x32_bf16 v[64:79], a[40:43], v[80:87], v2
    v_smfmac_f32_32x32x32_bf16 v[64:79], a[44:47], v[88:95], v2
    s_cmp_lt_u32 s59, 64
    s_cbranch_scc1 C_FB2
    s_nop 15
    s_branch C_FIN
L_END:
    s_endpgm
L_CODE_END:
.section .rodata,"a"
.p2align 6
.amdhsa_kernel gated_mix__linear_attn_block__mha_block__prompt_kernel
  .amdhsa_next_free_vgpr 256
  .amdhsa_next_free_sgpr 102
  .amdhsa_accum_offset 160
  .amdhsa_group_segment_fixed_size 0
  .amdhsa_kernarg_size 80
  .amdhsa_user_sgpr_count 2
  .amdhsa_user_sgpr_kernarg_segment_ptr 1
  .amdhsa_system_sgpr_workgroup_id_x 1
  .amdhsa_float_denorm_mode_32 3
.end_amdhsa_kernel
```
